```python
import torch

def _softmax(x, axis=-1):
    return torch.softmax(x, dim=axis)
def _gelu(x):
    return torch.nn.functional.gelu(x, approximate="tanh")
def _silu(x):
    return torch.nn.functional.silu(x)
def _sigmoid(x):
    return torch.sigmoid(x)
def _layernorm(x, axis=-1, eps=1e-5):
    m = x.mean(dim=axis, keepdim=True)
    v = x.var(dim=axis, keepdim=True, unbiased=False)
    return (x - m) / torch.sqrt(v + eps)
def _scatter_add(tgt, idx, src, axis=0):
    return tgt.clone().index_add_(axis, idx, src)
def _segment_sum(src, seg, n):
    out = torch.zeros((n,) + src.shape[1:], dtype=src.dtype)
    return out.index_add_(0, seg, src)
def _pad(x, pw):
    flat = tuple(v for pair in reversed(pw) for v in pair)
    return torch.nn.functional.pad(x, flat)

kernel_name = 'interleave_layers__compressed_kv_cla__dense_activation_gelu__decode'

def setup_inputs():

    _w = (lambda a: (lambda t: t.to(torch.bfloat16) if t.is_floating_point() else t)(torch.as_tensor(a)))
    def _A_setup():
        B, H, Sq, Sk, D, M = 1, 32, 1, 4096, 128, 640
        Dc = 4 * D
        return {
            "x": _w((lambda *s: torch.randn(*s, dtype=torch.bfloat16) * 0.05)(B, Sq, M)),
            "c_kv": _w((lambda *s: torch.randn(*s, dtype=torch.bfloat16) * 1.6)(B, Sk, Dc)),
            "w_q": _w((lambda *s: torch.randn(*s, dtype=torch.bfloat16) * 0.8)(M, H, D) * (M ** -0.5)),
            "w_uk": _w((lambda *s: torch.randn(*s, dtype=torch.bfloat16) * 0.8)(Dc, H, D) * (Dc ** -0.5)),
            "w_uv": _w((lambda *s: torch.randn(*s, dtype=torch.bfloat16) * 1.6)(Dc, H, D) * (Dc ** -0.5)),
            "w_o": _w((lambda *s: torch.randn(*s, dtype=torch.bfloat16) * 1.6)(H, D, M) * ((H * D) ** -0.5)),
        }
    _A_in = _A_setup()

    def _B_setup():
        B, S, D, F = 1, 1, 640, 1728
        return {
            "x": _w((lambda *s: torch.randn(*s, dtype=torch.bfloat16) * 0.05)(B, S, D)),
            "w1": _w((lambda *s: torch.randn(*s, dtype=torch.bfloat16) * 0.4)(D, F) * (D ** -0.5)),
            "b1": _w((lambda *s: torch.randn(*s, dtype=torch.bfloat16) * 0.4)(F) * 0.01),
            "w2": _w((lambda *s: torch.randn(*s, dtype=torch.bfloat16) * 0.4)(F, D) * (F ** -0.5)),
            "b2": _w((lambda *s: torch.randn(*s, dtype=torch.bfloat16) * 0.4)(D) * 0.01),
        }
    _B_in = _B_setup()

    return {
        "A_x": _A_in["x"],
        "A_c_kv": _A_in["c_kv"],
        "A_w_q": _A_in["w_q"],
        "A_w_uk": _A_in["w_uk"],
        "A_w_uv": _A_in["w_uv"],
        "A_w_o": _A_in["w_o"],
        "B_x": _B_in["x"],
        "B_w1": _B_in["w1"],
        "B_b1": _B_in["b1"],
        "B_w2": _B_in["w2"],
        "B_b2": _B_in["b2"],
    }

def reference(A_x, A_c_kv, A_w_q, A_w_uk, A_w_uv, A_w_o, B_x, B_w1, B_b1, B_w2, B_b2):
    def _A_ref(x, c_kv, w_q, w_uk, w_uv, w_o):
        B, Sq, M = x.shape[0], x.shape[1], x.shape[2]
        Sk = c_kv.shape[1]
        H, D = w_q.shape[1], w_q.shape[2]
        q = torch.einsum("bqm,mhd->bhqd", x, w_q)
        k = torch.einsum("bkc,chd->bhkd", c_kv, w_uk)
        v = torch.einsum("bkc,chd->bhkd", c_kv, w_uv)
        scores = torch.einsum("bhqd,bhkd->bhqk", q, k) * (D ** -0.5)
        off = Sk - Sq
        qi = torch.arange(Sq)[:, None]
        kj = torch.arange(Sk)[None, :]
        cmask = kj <= (qi + off)
        scores = torch.where(cmask[None, None], scores, -1e9)
        p = _softmax(scores, axis=-1)
        ctx = torch.einsum("bhqk,bhkd->bhqd", p, v)
        return torch.einsum("bhqd,hdm->bqm", ctx, w_o)

    def _B_ref(x, w1, b1, w2, b2):
        h = torch.einsum("bsd,df->bsf", x, w1) + b1
        h = _gelu(h)
        return torch.einsum("bsf,fd->bsd", h, w2) + b2

    x = A_x
    x = x + _A_ref(_layernorm(x, axis=-1), A_c_kv, A_w_q, A_w_uk, A_w_uv, A_w_o)
    x = x + _B_ref(_layernorm(x, axis=-1), B_w1, B_b1, B_w2, B_b2)
    x = x + _A_ref(_layernorm(x, axis=-1), A_c_kv, A_w_q, A_w_uk, A_w_uv, A_w_o)
    x = x + _B_ref(_layernorm(x, axis=-1), B_w1, B_b1, B_w2, B_b2)
    return x
```

```asm
; @launch grid=(256,1,1) block=(256,1,1) lds=163840
.amdgcn_target "amdgcn-amd-amdhsa--gfx950"
.text
.globl interleave_layers__compressed_kv_cla__dense_activation_gelu__decode_kernel
.p2align 8
.type interleave_layers__compressed_kv_cla__dense_activation_gelu__decode_kernel,@function
interleave_layers__compressed_kv_cla__dense_activation_gelu__decode_kernel:
    s_cmp_ge_u32 s2, 256
    s_cbranch_scc1 L_end
    s_memrealtime s[100:101]
    s_getpc_b64 s[56:57]
L_pc:
    s_bfe_u32 s58, s2, 0x30003
    v_and_b32 v110, 0xf8, v0
    v_add_lshl_u32 v110, v110, s58, 7
    v_min_u32 v110, L_codeend-L_pc-4, v110
    v_mov_b32 v111, s57
    v_add_co_u32 v110, vcc, s56, v110
    s_nop 1
    v_addc_co_u32 v111, vcc, 0, v111, vcc
    global_load_dword v149, v[110:111], off
    s_load_dwordx2 s[52:53], s[0:1], 104
    s_load_dwordx2 s[12:13], s[0:1], 16
    s_load_dwordx2 s[4:5], s[0:1], 0
    s_load_dwordx2 s[8:9], s[0:1], 8
    s_load_dwordx2 s[16:17], s[0:1], 24
    s_load_dwordx2 s[32:33], s[0:1], 64
    s_load_dwordx2 s[40:41], s[0:1], 80
    s_load_dwordx2 s[20:21], s[0:1], 32
    s_load_dwordx2 s[24:25], s[0:1], 40
    s_load_dwordx2 s[28:29], s[0:1], 56
    s_load_dwordx2 s[36:37], s[0:1], 72
    s_load_dwordx2 s[44:45], s[0:1], 88
    v_lshrrev_b32 v110, 6, v0
    s_and_b32 s56, s2, 7
    s_lshr_b32 s57, s2, 3
    v_readfirstlane_b32 s58, v110
    v_and_b32 v2, 15, v0
    v_bfe_u32 v3, v0, 4, 2
    s_and_b32 s60, s57, 7
    s_lshr_b32 s61, s57, 3
    s_lshl_b32 s59, s56, 2
    s_add_u32 s59, s59, s61
    s_lshl_b32 s67, s56, 5
    s_add_u32 s67, s67, s57
    s_lshl_b32 s65, s67, 4
    s_mov_b32 s54, 10485760
    s_mov_b32 s55, 0x20000
    s_mov_b32 s14, 5242880
    s_mov_b32 s15, 0x20000
    s_lshl_b32 s99, s58, 10
    v_mov_b32 v150, 1073741824
    v_mov_b32 v152, -1
    v_mov_b32 v153, -1
    v_mov_b32 v154, -1
    v_mov_b32 v155, -1
    v_lshlrev_b32 v72, 4, v2
    s_lshl_b32 s68, s59, 6
    s_add_u32 s68, s68, s60
    s_lshl_b32 s68, s68, 5
    v_and_b32 v85, 3, v2
    s_and_b32 s90, s67, 192
    s_add_u32 s90, s90, s67
    s_lshl_b32 s90, s90, 7
    s_add_u32 s90, s90, 196608
    s_mov_b32 s98, 720896
    v_lshl_add_u32 v75, s65, 4, v72
    v_mad_u32_u24 v140, v3, s98, v75
    v_add_u32 v73, s90, v72
    v_cmp_lt_u32 vcc, 31, v0
    s_add_u32 s66, s65, 343936
    s_cmp_eq_u32 s60, 0
    s_cselect_b32 s66, s66, 536870912
    v_add_u32 v74, s66, v72
    v_cndmask_b32 v140, v140, v73, vcc
    v_cmp_lt_u32 vcc, 39, v0
    s_lshr_b32 s91, s58, 1
    s_lshl_b32 s66, s91, 7
    v_cndmask_b32 v140, v140, v74, vcc
    v_cmp_lt_u32 vcc, 47, v0
    v_lshlrev_b32 v73, 5, v3
    v_xor_b32 v73, v73, v72
    v_cndmask_b32 v140, v140, v150, vcc
    v_xor_b32 v78, s66, v73
    v_lshl_add_u32 v109, v3, 13, v78
    s_lshl_b32 s66, s60, 2
    s_add_u32 s91, s91, s66
    s_add_u32 s92, s91, 2
    s_mul_i32 s64, s91, 43
    s_lshr_b32 s64, s64, 7
    s_mul_i32 s66, s64, 3
    s_sub_u32 s66, s91, s66
    s_min_u32 s66, s66, 1
    s_add_u32 s64, s64, s66
    s_mul_i32 s91, s91, 5
    s_add_u32 s64, s64, s91
    s_lshl_b32 s64, s64, 2
    s_mul_i32 s73, s92, 43
    s_lshr_b32 s73, s73, 7
    s_mul_i32 s93, s73, 3
    s_sub_u32 s93, s92, s93
    s_min_u32 s93, s93, 1
    s_add_u32 s73, s73, s93
    s_mul_i32 s92, s92, 5
    s_add_u32 s73, s73, s92
    s_lshl_b32 s73, s73, 2
    s_and_b32 s91, s58, 1
    s_and_b32 s66, s66, s91
    s_and_b32 s93, s93, s91
    s_mul_i32 s91, s91, 384
    s_add_u32 s91, s91, s59
    s_lshl_b32 s64, s64, 5
    s_add_u32 s64, s64, s91
    s_lshl_b32 s64, s64, 8
    s_lshl_b32 s73, s73, 5
    s_add_u32 s73, s73, s91
    s_lshl_b32 s73, s73, 8
    s_lshl_b32 s66, s66, 29
    s_lshl_b32 s93, s93, 29
    s_waitcnt lgkmcnt(0)
    buffer_store_dwordx4 v[152:155], v140, s[52:55], 0 offen sc1
    s_barrier
    s_add_u32 m0, s99, 131072
    s_nop 0
    buffer_load_dwordx4 v109, s[12:15], s64 offen lds
    s_add_u32 m0, s99, 135168
    s_nop 0
    buffer_load_dwordx4 v109, s[12:15], s73 offen lds
    s_add_u32 m0, s99, 139264
    s_add_u32 s64, s64, 32768
    buffer_load_dwordx4 v109, s[12:15], s64 offen lds
    s_add_u32 m0, s99, 143360
    s_add_u32 s73, s73, 32768
    buffer_load_dwordx4 v109, s[12:15], s73 offen lds
    s_add_u32 m0, s99, 147456
    s_add_u32 s64, s64, 32768
    s_add_u32 s64, s64, s66
    buffer_load_dwordx4 v109, s[12:15], s64 offen lds
    s_add_u32 m0, s99, 151552
    s_add_u32 s73, s73, 32768
    s_add_u32 s73, s73, s93
    buffer_load_dwordx4 v109, s[12:15], s73 offen lds
    s_mov_b32 s6, 1280
    s_mov_b32 s7, 0x20000
    s_mov_b32 s18, 4194304
    s_mov_b32 s19, 0x20000
    s_lshl_b32 s66, s60, 2
    v_add_u32 v79, s66, v3
    v_mul_u32_u24 v80, 43, v79
    v_lshrrev_b32 v80, 7, v80
    v_mul_u32_u24 v81, 3, v80
    v_sub_u32 v81, v79, v81
    v_min_u32 v81, 1, v81
    v_add_u32 v80, v80, v81
    v_mad_u32_u24 v80, v79, 5, v80
    v_cmp_gt_u32 vcc, 3, v2
    v_add_lshl_u32 v80, v80, v2, 3
    v_add_u32 v81, v81, v2
    v_cndmask_b32 v80, v150, v80, vcc
    v_cmp_gt_u32 vcc, 3, v81
    buffer_load_dwordx2 v[180:181], v80, s[4:7], 0 offen
    s_nop 0
    v_cndmask_b32 v80, v150, v80, vcc
    buffer_load_dwordx2 v[182:183], v80, s[4:7], 0 offen offset:24
    s_mov_b32 s10, 4194304
    s_mov_b32 s11, 0x20000
    v_lshrrev_b32 v82, 1, v3
    v_and_b32 v83, 1, v3
    v_lshl_add_u32 v92, v83, 1, v82
    v_xor_b32 v82, v2, v92
    v_lshlrev_b32 v82, 4, v82
    v_lshl_add_u32 v88, v3, 10, v82
    v_xor_b32 v89, 64, v88
    v_xor_b32 v90, 128, v88
    v_xor_b32 v91, 192, v88
    s_lshl_b32 s62, s58, 15
    s_lshl_b32 s87, s58, 8
    s_lshl_b32 s85, s65, 10
    s_add_u32 s85, s85, s87
    s_getreg_b32 s72, hwreg(HW_REG_XCC_ID)
    s_lshl_b32 s72, s72, 28
    s_lshl_b32 s66, s65, 3
    s_add_u32 s66, s66, 917504
    v_and_b32 v82, 56, v0
    v_lshl_add_u32 v82, v82, 22, v72
    v_add_u32 v169, s66, v82
    s_cmp_eq_u32 s58, 0
    s_cselect_b32 s49, 0, 536870912
    s_mov_b32 s48, 536870912
    s_sub_u32 s100, s100, 250
    s_subb_u32 s101, s101, 0
    s_mov_b32 s3, 4000
    s_mov_b32 s75, 4096
    v_and_b32 v1, 63, v0
    v_and_b32 v76, 7, v2
    v_lshl_add_u32 v145, v3, 17, v78
    v_mov_b32 v141, 0x3f803f80
    v_cmp_eq_u32 s[96:97], 7, v2
    v_and_b32 v82, 1, v2
    s_nop 0
    v_cndmask_b32 v8, 0, v141, s[96:97]
    v_mul_u32_u24 v83, 0xaaaa, v82
    v_add_u32 v7, 0x4444, v83
    v_mov_b32 v184, v141
    v_mov_b32 v185, v141
    v_mov_b32 v186, v141
    v_mov_b32 v187, v141
    s_mov_b32 s63, 0
    s_mov_b32 s69, 200
    s_mov_b32 s80, -1
    s_mov_b32 s81, 0
    s_mov_b32 s78, 0x00080008
    s_mov_b32 s79, 0x00080008
    v_xor_b32 v84, 32, v0
    v_mul_u32_u24 v83, 7, v84
    v_mul_u32_u24 v84, v84, v84
    v_cmp_eq_u32 vcc, v83, v84
    v_and_b32 v83, 4, v0
    s_add_u32 s66, s65, 344064
    v_add_u32 v83, s66, v83
    v_cndmask_b32 v5, v150, v83, vcc
    s_lshl_b32 s66, s59, 7
    s_add_u32 s66, s66, 344064
    v_lshl_add_u32 v6, v76, 4, s66
    v_lshrrev_b32 v86, 2, v2
    v_lshl_add_u32 v84, v86, 1, v82
    v_bfe_u32 v83, v2, 1, 1
    v_lshl_add_u32 v111, v83, 3, v84
    s_lshl_b32 s66, s58, 9
    s_add_u32 s66, s66, s68
    v_lshl_add_u32 v83, v111, 1, s66
    v_and_b32 v84, 33, v1
    v_cmp_eq_u32 vcc, 0, v84
    v_lshl_add_u32 v84, v3, 8, v83
    v_lshrrev_b32 v87, 3, v2
    v_cndmask_b32 v170, v5, v84, vcc
    v_and_b32 v84, 17, v1
    v_cmp_eq_u32 vcc, 0, v84
    v_lshl_add_u32 v84, v3, 7, v83
    v_add_u32 v84, 65536, v84
    v_cndmask_b32 v19, v150, v84, vcc
    s_lshl_b32 s66, s59, 11
    v_lshl_add_u32 v171, v1, 4, s66
    s_lshl_b32 s66, s56, 2
    s_add_u32 s66, s66, s58
    s_lshl_b32 s66, s66, 11
    s_add_u32 s66, s66, 65536
    v_lshl_add_u32 v20, v1, 4, s66
    s_lshl_b32 s66, s58, 6
    v_lshl_add_u32 v83, v3, 3, v86
    v_and_b32 v84, 1, v3
    v_lshl_add_u32 v84, v84, 2, v86
    v_lshlrev_b32 v84, 5, v84
    v_xor_b32 v84, s66, v84
    v_lshl_add_u32 v84, v83, 8, v84
    v_lshl_add_u32 v84, v85, 3, v84
    v_add_u32 v177, 131072, v84
    v_xor_b32 v178, 32, v177
    s_lshl_b32 s66, s59, 3
    v_add_u32 v80, s66, v76
    s_lshl_b32 s66, s60, 4
    s_add_u32 s66, s66, s58
    s_lshl_b32 s66, s66, 1
    v_and_b32 v81, 6, v2
    v_lshl_add_u32 v81, v81, 2, v82
    v_cmp_lt_u32 vcc, 7, v2
    v_add_u32 v81, s66, v81
    v_lshlrev_b32 v84, 24, v3
    v_cndmask_b32 v80, v80, v81, vcc
    v_lshl_add_u32 v80, v80, 7, v84
    v_add_u32 v157, 917504, v80
    s_waitcnt vmcnt(8)
    s_memrealtime s[88:89]
    s_waitcnt lgkmcnt(0)
    v_mov_b32 v216, s88
    v_mov_b32 v217, s89
    v_mov_b32 v218, s88
    v_or_b32 v219, s72, v217
    buffer_store_dwordx4 v[216:219], v169, s[52:55], s49 offen sc1
    buffer_load_dword v149, v140, s[52:55], 0 offen sc1
    s_lshl_b32 s64, s60, 2
    s_add_u32 s64, s64, s58
    s_lshl_b32 s64, s64, 9
    s_add_u32 s64, s64, s59
    s_lshl_b32 s64, s64, 8
    v_mul_u32_u24 v144, 7168, v3
    v_add_u32 v132, v91, v144
    s_add_u32 m0, s62, 28672
    s_nop 0
    buffer_load_dwordx4 v132, s[16:19], s64 offen lds
    s_lshl_b32 s67, s58, 5
    v_lshl_add_u32 v84, v111, 1, s67
    v_add_u32 v162, 155648, v84
    v_and_b32 v83, 17, v1
    v_cmp_eq_u32 vcc, 0, v83
    v_lshl_add_u32 v84, v3, 12, v84
    v_add_u32 v84, s90, v84
    v_add_u32 v83, s90, v72
    v_cndmask_b32 v13, v150, v84, vcc
    v_cmp_gt_u32 vcc, 8, v0
    s_and_b32 s93, s60, 6
    s_add_u32 s93, s93, s60
    v_cndmask_b32 v21, v150, v83, vcc
    s_lshl_b32 s93, s93, 12
    s_add_u32 s67, s93, s87
    s_add_u32 s67, s67, 196608
    v_cmp_gt_u32 vcc, 2, v85
    v_lshlrev_b32 v83, 4, v85
    v_lshl_add_u32 v83, v3, 5, v83
    v_lshl_add_u32 v83, v86, 10, v83
    v_add_u32 v83, s67, v83
    v_cndmask_b32 v14, v150, v83, vcc
    s_lshl_b32 s91, s59, 7
    s_add_u32 s93, s93, s91
    s_add_u32 s93, s93, 262144
    v_mul_u32_u24 v83, 20, v3
    v_sub_u32 v83, v0, v83
    v_cmp_gt_u32 vcc, 2, v83
    v_lshl_add_u32 v83, v83, 10, v3
    v_lshl_add_u32 v83, v83, 3, s93
    s_lshl_b32 s66, s60, 18
    v_cndmask_b32 v16, v150, v83, vcc
    s_lshl_b32 s67, s58, 14
    s_add_u32 s66, s66, s67
    s_add_u32 s66, s66, s91
    s_add_u32 s66, s66, 4194304
    v_lshlrev_b32 v83, 12, v87
    v_lshl_add_u32 v83, v3, 16, v83
    v_lshl_add_u32 v83, v76, 4, v83
    v_add_u32 v15, s66, v83
    v_bfe_u32 v81, v2, 1, 1
    v_lshl_add_u32 v83, v82, 1, v81
    v_and_b32 v84, 12, v2
    v_or_b32 v83, v83, v84
    v_xor_b32 v83, v83, v3
    v_lshlrev_b32 v83, 4, v83
    v_lshl_add_u32 v83, v2, 8, v83
    v_add_u32 v133, v90, v144
    s_add_u32 m0, s62, 29696
    s_add_u32 s64, s64, 32768
    buffer_load_dwordx4 v133, s[16:19], s64 offen lds
    v_add_u32 v96, s62, v83
    v_xor_b32 v97, 64, v96
    v_xor_b32 v98, 128, v96
    v_xor_b32 v99, 192, v96
    v_xor_b32 v81, v81, v92
    v_or_b32 v81, v81, v84
    v_lshlrev_b32 v81, 4, v81
    v_lshl_add_u32 v81, v82, 3, v81
    v_lshl_add_u32 v83, v84, 2, v3
    v_lshl_add_u32 v81, v83, 8, v81
    v_add_u32 v100, s62, v81
    v_xor_b32 v101, 32, v100
    v_xor_b32 v102, 64, v100
    v_xor_b32 v103, 96, v100
    v_xor_b32 v104, 128, v100
    v_xor_b32 v105, 160, v100
    v_xor_b32 v106, 192, v100
    v_xor_b32 v107, 224, v100
    s_lshl_b32 s66, s58, 6
    s_lshl_b32 s92, s56, 13
    s_add_u32 s92, s92, 131072
    s_add_u32 s67, s92, s87
    v_lshl_add_u32 v83, v3, 11, v72
    v_add_u32 v25, s67, v83
    s_lshl_b32 s67, s60, 10
    s_add_u32 s92, s92, s67
    s_lshl_b32 s67, s61, 8
    s_add_u32 s92, s92, s67
    s_add_u32 s67, s92, s66
    v_cmp_gt_u32 vcc, 16, v1
    v_lshl_add_u32 v83, v1, 2, s67
    v_add_u32 v84, 8, v5
    v_cndmask_b32 v24, v84, v83, vcc
    v_add_u32 v77, s58, v3
    v_and_b32 v77, 1, v77
    s_lshl_b32 s91, s57, 7
    s_add_u32 s91, s91, 327680
    v_lshlrev_b32 v83, 2, v2
    v_lshl_add_u32 v83, v77, 6, v83
    v_cmp_gt_u32 vcc, 128, v0
    v_add_u32 v83, s91, v83
    v_lshrrev_b32 v84, 1, v3
    v_cndmask_b32 v179, v150, v83, vcc
    v_cmp_gt_u32 vcc, 64, v0
    v_lshl_add_u32 v83, v84, 13, v83
    v_and_b32 v84, 0x90, v0
    v_add_u32 v134, v89, v144
    s_add_u32 m0, s62, 30720
    s_add_u32 s64, s64, 32768
    buffer_load_dwordx4 v134, s[16:19], s64 offen lds
    v_cndmask_b32 v22, v150, v83, vcc
    v_cmp_eq_u32 vcc, 0, v84
    s_cmp_eq_u32 s56, 0
    s_cselect_b32 s74, -1, 0
    v_cndmask_b32 v23, v150, v83, vcc
    v_cmp_gt_u32 vcc, 4, v2
    v_lshl_add_u32 v83, v79, 7, v72
    v_add_u32 v83, 327680, v83
    v_cndmask_b32 v168, v150, v83, vcc
    v_cndmask_b32 v4, v150, v23, s[80:81]
    v_cmp_eq_u32 vcc, 15, v2
    v_lshrrev_b32 v79, 3, v0
    v_mad_u32_u24 v83, v77, 12, v2
    v_cndmask_b32 v28, 0, 1.0, vcc
    v_lshlrev_b32 v147, 1, v83
    s_mov_b32 s66, 360448
    v_min_u32 v80, 1, v3
    v_mad_u32_u24 v80, v80, s66, v75
    v_add_u32 v81, 65536, v80
    v_cndmask_b32 v80, v80, v81, s[80:81]
    v_add_u32 v83, 360576, v74
    v_cmp_lt_u32 vcc, 47, v0
    v_add_u32 v81, s92, v72
    v_mad_u32_u24 v81, v3, s66, v81
    v_cndmask_b32 v80, v80, v83, vcc
    v_cmp_lt_u32 vcc, 63, v0
    v_lshlrev_b32 v83, 4, v76
    v_lshl_add_u32 v84, v87, 13, v83
    v_cndmask_b32 v80, v80, v81, vcc
    v_add_u32 v81, s93, v84
    v_mad_u32_u24 v81, v3, s66, v81
    s_add_u32 s67, s90, 360448
    v_add_u32 v84, s67, v84
    v_cndmask_b32 v81, v84, v81, s[80:81]
    v_cmp_eq_u32 vcc, 3, v3
    v_subrev_u32 v84, 352256, v84
    s_nop 0
    v_cndmask_b32 v81, v81, v84, vcc
    v_cmp_lt_u32 vcc, 127, v0
    s_lshr_b32 s67, s56, 2
    s_mul_i32 s67, s67, 344064
    v_cndmask_b32 v80, v80, v81, vcc
    s_lshl_b32 s66, s56, 12
    s_add_u32 s67, s67, s66
    s_add_u32 s67, s67, s91
    v_cmp_lt_u32 vcc, 191, v0
    v_add_u32 v81, s67, v83
    v_add_u32 v135, v88, v144
    s_add_u32 m0, s62, 31744
    s_add_u32 s64, s64, 32768
    buffer_load_dwordx4 v135, s[16:19], s64 offen lds
    s_lshl_b32 s66, s58, 3
    v_cndmask_b32 v80, v80, v81, vcc
    v_cndmask_b32 v136, -1, 0, vcc
    v_cndmask_b32 v137, -1, 0, vcc
    v_cndmask_b32 v138, -1, 0, vcc
    v_cndmask_b32 v139, -1, 0, vcc
    s_lshr_b32 s67, 0x08383038, s66
    s_and_b32 s67, s67, 0xff
    v_cmp_gt_u32 vcc, s67, v1
    s_add_u32 s67, s66, 158720
    v_lshrrev_b32 v81, 1, v3
    v_cndmask_b32 v160, v150, v80, vcc
    v_lshl_add_u32 v81, v81, 4, v2
    v_and_b32 v83, 1, v3
    v_lshlrev_b32 v83, 2, v83
    v_lshl_add_u32 v81, v81, 5, v83
    v_add_u32 v30, s67, v81
    v_lshl_add_u32 v81, v2, 2, v92
    s_add_u32 s66, s66, s56
    s_lshl_b32 s66, s66, 7
    v_lshl_add_u32 v146, v81, 1, s66
    s_lshl_b32 s67, s58, 7
    s_add_u32 s67, s67, 157952
    v_and_b32 v81, 1, v3
    v_lshl_add_u32 v81, v81, 2, v85
    v_lshl_add_u32 v81, v86, 3, v81
    v_lshrrev_b32 v83, 1, v3
    v_lshl_add_u32 v81, v81, 1, v83
    v_lshl_add_u32 v9, v81, 1, s67
    v_lshl_add_u32 v81, v3, 1, v82
    v_lshlrev_b32 v81, 4, v81
    v_add_u32 v254, 157952, v81
    s_mov_b32 s22, 4194304
    s_mov_b32 s23, 0x20000
    s_mov_b32 s26, 5242880
    s_mov_b32 s27, 0x20000
    s_mov_b32 s30, 2211840
    s_mov_b32 s31, 0x20000
    s_mov_b32 s38, 2211840
    s_mov_b32 s39, 0x20000
    s_mov_b32 s34, 3456
    s_mov_b32 s35, 0x20000
    s_mov_b32 s42, 1280
    s_mov_b32 s43, 0x20000
    s_mov_b32 s46, 1280
    s_mov_b32 s47, 0x20000
    v_lshl_add_u32 v116, v87, 24, v157
    buffer_load_dwordx4 v[240:243], v116, s[52:55], 0 offen sc1
    s_mov_b32 s66, s57
    s_mul_i32 s86, s66, 43
    s_lshr_b32 s86, s86, 7
    s_mul_i32 s67, s86, 3
    s_sub_u32 s67, s66, s67
    s_min_u32 s67, s67, 1
    s_add_u32 s86, s86, s67
    s_mul_i32 s66, s66, 5
    s_add_u32 s86, s86, s66
    s_lshl_b32 s86, s86, 2
    s_lshl_b32 s86, s86, 1
    s_lshl_b32 s92, s67, 4
    s_sub_u32 s92, 40, s92
    s_lshl_b32 s67, s67, 2
    v_mul_u32_u24 v81, s67, v77
    s_cmp_lt_u32 s57, 30
    s_cselect_b32 s86, s86, 536870912
    s_cselect_b32 s66, 12, 0
    v_sub_u32 v81, s66, v81
    v_cmp_lt_i32 s[82:83], v2, v81
    v_lshl_add_u32 v81, v3, 24, v147
    s_nop 0
    v_cndmask_b32 v167, v150, v81, s[82:83]
    s_lshl_b32 s66, s60, 2
    s_add_u32 s66, s66, s58
    s_mul_i32 s95, s66, 43
    s_lshr_b32 s95, s95, 7
    s_mul_i32 s67, s95, 3
    s_sub_u32 s67, s66, s67
    s_min_u32 s67, s67, 1
    s_add_u32 s95, s95, s67
    s_mul_i32 s66, s66, 5
    s_add_u32 s95, s95, s66
    s_lshl_b32 s95, s95, 2
    s_mul_i32 s95, s95, 27
    s_lshl_b32 s66, s61, 3
    s_add_u32 s66, s66, s56
    s_add_u32 s95, s95, s66
    s_lshl_b32 s95, s95, 7
    s_cmp_lt_u32 s66, 27
    s_cselect_b32 s95, s95, 536870912
    v_lshrrev_b32 v80, 5, v1
    v_bfe_u32 v81, v1, 3, 2
    v_mad_u32_u24 v81, v80, 12, v81
    v_mul_u32_u24 v81, 3456, v81
    v_lshl_add_u32 v165, v76, 4, v81
    v_and_b32 v81, s67, v80
    v_lshl_add_u32 v163, v81, 30, v165
    v_lshlrev_b32 v81, 1, v80
    v_xor_b32 v81, v85, v81
    v_lshrrev_b32 v83, 1, v81
    v_lshlrev_b32 v81, 4, v81
    v_lshlrev_b32 v83, 3, v83
    v_sub_u32 v81, v81, v83
    v_min_u32 v81, s92, v81
    v_lshrrev_b32 v83, 2, v1
    v_mul_u32_u24 v83, 1280, v83
    v_add_u32 v164, v83, v81
    s_mul_i32 s66, s57, 43
    s_lshr_b32 s66, s66, 7
    s_mul_i32 s66, s66, 3
    s_sub_u32 s66, s57, s66
    s_lshr_b32 s94, 8, s66
    s_and_b32 s94, s94, 7
    s_lshl_b32 s68, s56, 2
    s_add_u32 s68, s68, s58
    s_mul_i32 s68, s68, 163840
    s_add_u32 s68, s68, s86
    s_lshl_b32 s92, s58, 3
    s_add_u32 s92, s92, s56
    s_mul_i32 s92, s92, 81920
    s_add_u32 s92, s92, s86
    s_and_b32 s66, s58, 1
    s_cselect_b32 s93, s90, s93
    s_lshr_b32 s66, s58, 1
    s_mul_i32 s66, s66, 360448
    s_add_u32 s93, s93, s66
    s_add_u32 s93, s93, 8192
    s_lshl_b32 s67, s58, 11
    s_add_u32 s67, s67, 147456
    v_lshlrev_b32 v81, 2, v80
    v_xor_b32 v81, v1, v81
    v_lshl_add_u32 v10, v81, 4, s67
    v_and_b32 v81, 14, v2
    v_lshlrev_b32 v81, 2, v81
    v_lshl_add_u32 v81, v3, 1, v81
    v_lshlrev_b32 v83, 2, v87
    v_xor_b32 v81, v81, v83
    v_mad_u32_u24 v81, v82, 64, v81
    v_add_lshl_u32 v81, v81, v82, 4
    v_add_u32 v11, 147456, v81
    s_and_b32 s67, s65, 0xfe0
    s_add_u32 s66, s65, s67
    s_lshl_b32 s66, s66, 8
    s_add_u32 s66, s66, 4194304
    v_lshl_add_u32 v17, v0, 4, s66
    v_bfe_u32 v81, v0, 4, 3
    v_xor_b32 v81, v0, v81
    v_lshlrev_b32 v81, 4, v81
    v_add_u32 v173, 159744, v81
    v_lshrrev_b32 v81, 1, v2
    v_xor_b32 v81, v81, v3
    v_lshlrev_b32 v81, 4, v81
    v_lshl_add_u32 v81, v2, 7, v81
    v_add_u32 v174, 159744, v81
    s_and_b32 s66, s56, 6
    s_add_u32 s66, s66, s56
    s_lshl_b32 s66, s66, 12
    s_lshl_b32 s67, s61, 3
    s_add_u32 s66, s66, s67
    s_add_u32 s66, s66, 262144
    v_lshl_add_u32 v18, v79, 7, s66
    v_lshlrev_b32 v81, 3, v79
    v_add_u32 v12, 157440, v81
    v_lshl_add_u32 v81, v3, 2, v85
    v_bfe_u32 v83, v2, 2, 1
    v_lshl_add_u32 v81, v83, 4, v81
    v_lshlrev_b32 v81, 3, v81
    v_add_u32 v255, 157440, v81
    v_cmp_lt_u32 vcc, 7, v2
    v_lshlrev_b32 v84, 24, v3
    s_lshl_b32 s66, s58, 6
    s_add_u32 s66, s66, s56
    v_lshl_add_u32 v80, v76, 3, s66
    s_lshl_b32 s66, s56, 2
    s_add_u32 s66, s66, s58
    s_lshl_b32 s66, s66, 3
    v_add_u32 v81, s66, v76
    v_cndmask_b32 v80, v80, v81, vcc
    s_lshl_b32 s66, s60, 2
    v_add_u32 v81, s66, v85
    v_mov_b32 v108, s57
    v_cndmask_b32 v81, v81, v108, vcc
    v_bfe_u32 v108, v2, 2, 1
    v_lshl_add_u32 v81, v108, 6, v81
    v_cmp_eq_u32 vcc, 1, v3
    v_and_b32 v84, 0x2000000, v84
    v_add_u32 v84, 950272, v84
    v_cndmask_b32 v80, v80, v81, vcc
    v_lshl_add_u32 v158, v80, 7, v84
    v_and_b32 v83, 31, v1
    v_lshlrev_b32 v83, 5, v83
    v_add_u32 v31, 158720, v83
    s_waitcnt vmcnt(9)
    s_waitcnt vmcnt(7)
    s_barrier
    ds_read_b64_tr_b16 v[32:33], v177 offset:0
    ds_read_b64_tr_b16 v[34:35], v177 offset:1024
    ds_read_b64_tr_b16 v[36:37], v178 offset:0
    ds_read_b64_tr_b16 v[38:39], v178 offset:1024
    ds_read_b64_tr_b16 v[40:41], v177 offset:8192
    ds_read_b64_tr_b16 v[42:43], v177 offset:9216
    ds_read_b64_tr_b16 v[44:45], v178 offset:8192
    ds_read_b64_tr_b16 v[46:47], v178 offset:9216
    ds_read_b64_tr_b16 v[48:49], v177 offset:16384
    ds_read_b64_tr_b16 v[50:51], v177 offset:17408
    ds_read_b64_tr_b16 v[52:53], v178 offset:16384
    ds_read_b64_tr_b16 v[54:55], v178 offset:17408
    s_waitcnt lgkmcnt(8)
    v_mfma_f32_16x16x32_bf16 v[196:199], v[180:183], v[32:35], 0
    v_or_b32 v220, v180, v8
    v_or_b32 v221, v181, v8
    v_mfma_f32_16x16x32_bf16 v[200:203], v[180:183], v[36:39], 0
    v_or_b32 v222, v182, v8
    v_or_b32 v223, v183, v8
    s_waitcnt lgkmcnt(4)
    v_mfma_f32_16x16x32_bf16 v[204:207], v[180:183], v[40:43], 0
    v_mfma_f32_16x16x32_bf16 v[224:227], v[180:183], v[220:223], 0
    v_mfma_f32_16x16x32_bf16 v[208:211], v[180:183], v[44:47], 0
    s_waitcnt lgkmcnt(0)
    v_mfma_f32_16x16x32_bf16 v[212:215], v[180:183], v[48:51], 0
    v_mfma_f32_16x16x32_bf16 v[216:219], v[180:183], v[52:55], 0
    v_mfma_f32_16x16x32_bf16 v[244:247], v[184:187], v[32:35], 0
    v_mfma_f32_16x16x32_bf16 v[248:251], v[184:187], v[36:39], 0
    v_mfma_f32_16x16x32_bf16 v[244:247], v[184:187], v[40:43], v[244:247]
    v_mfma_f32_16x16x32_bf16 v[248:251], v[184:187], v[44:47], v[248:251]
    v_mfma_f32_16x16x32_bf16 v[244:247], v[184:187], v[48:51], v[244:247]
    v_mfma_f32_16x16x32_bf16 v[248:251], v[184:187], v[52:55], v[248:251]
    v_add_f32 v196, v196, v205
    v_add_f32 v200, v200, v209
    v_add_f32 v229, v224, v225
    v_add_f32_dpp v228, v225, v224 quad_perm:[1,1,1,1] row_mask:0xf bank_mask:0xf
    v_add_f32 v229, v229, v226
    v_add_f32 v196, v196, v214
    v_add_f32_dpp v228, v226, v228 quad_perm:[2,2,2,2] row_mask:0xf bank_mask:0xf
    v_add_f32 v200, v200, v218
    v_cndmask_b32 v228, v228, v229, s[96:97]
    s_nop 0
    v_permlane16_swap_b32 v196, v200
    v_permlane32_swap_b32 v229, v228
    s_nop 0
    v_mov_b32_dpp v197, v196 quad_perm:[1,0,3,2] row_mask:0xf bank_mask:0xf
    v_cvt_pk_bf16_f32 v196, v196, v197
    v_cndmask_b32 v196, v229, v196, s[80:81]
    v_min_u32 v196, -2, v196
    s_waitcnt vmcnt(0)
L_fl_1:
    v_mov_b32 v194, s101
    v_subrev_co_u32 v192, vcc, s100, v240
    s_nop 1
    v_subb_co_u32 v193, vcc, v241, v194, vcc
    v_lshrrev_b32 v192, 24, v192
    v_or_b32 v192, v192, v193
    v_cmp_ne_u32 vcc, 0, v192
    s_and_b32 s66, vcc_lo, 0xff
    s_cbranch_scc1 L_rt_2
    v_and_b32 v243, 0xf0000000, v243
    v_cmp_ne_u32 vcc, s72, v243
    s_and_b32 s66, vcc_lo, 0xff
    s_cselect_b32 s70, 536870912, 0
    s_cselect_b32 s84, 0, 536870912
    buffer_store_dword v196, v170, s[52:55], s70 offen
    buffer_store_dword v196, v170, s[52:55], s84 offen sc1
    v_permlane16_swap_b32 v244, v248
    s_nop 1
    v_mov_b32_dpp v245, v244 quad_perm:[1,0,3,2] row_mask:0xf bank_mask:0xf
    v_cvt_pk_bf16_f32 v244, v244, v245
    v_min_u32 v244, -2, v244
    v_add_u32 v245, s98, v170
    buffer_store_dword v244, v245, s[52:55], s70 offen
    buffer_store_dword v244, v245, s[52:55], s84 offen sc1
    s_barrier
    s_add_u32 m0, s62, 0
    s_xor_b32 s76, s85, 0
    buffer_load_dwordx4 v88, s[8:11], s76 offen lds
    s_add_u32 m0, s62, 1024
    s_xor_b32 s76, s85, 4096
    buffer_load_dwordx4 v89, s[8:11], s76 offen lds
    s_add_u32 m0, s62, 2048
    s_xor_b32 s76, s85, 8192
    buffer_load_dwordx4 v90, s[8:11], s76 offen lds
    s_add_u32 m0, s62, 3072
    s_xor_b32 s76, s85, 12288
    buffer_load_dwordx4 v91, s[8:11], s76 offen lds
    buffer_load_dwordx4 v[232:235], v171, s[52:55], s98 offen offset:0 sc1
    buffer_load_dwordx4 v[236:239], v171, s[52:55], s98 offen offset:1024 sc1
    buffer_load_dwordx4 v[184:187], v171, s[52:55], s63 offen offset:0 sc1
    buffer_load_dwordx4 v[188:191], v171, s[52:55], s63 offen offset:1024 sc1
    buffer_load_dwordx2 v[230:231], v6, s[52:55], s63 offen offset:0 sc1
    s_lshr_b32 s64, s60, 1
    s_lshl_b32 s64, s64, 7
    s_and_b32 s73, s60, 1
    s_lshl_b32 s73, s73, 3
    s_add_u32 s64, s64, s73
    s_and_b32 s73, s58, 1
    s_lshl_b32 s73, s73, 6
    s_add_u32 s64, s64, s73
    s_lshr_b32 s73, s58, 1
    s_add_u32 s64, s64, s73
    s_lshl_b32 s64, s64, 5
    s_add_u32 s64, s64, s59
    s_lshl_b32 s64, s64, 8
    s_add_u32 m0, s99, 131072
    s_nop 0
    buffer_load_dwordx4 v145, s[20:23], s64 offen lds
    s_add_u32 m0, s99, 135168
    s_add_u32 s64, s64, 16384
    buffer_load_dwordx4 v145, s[20:23], s64 offen lds
    s_add_u32 m0, s99, 139264
    s_add_u32 s64, s64, 16384
    buffer_load_dwordx4 v145, s[20:23], s64 offen lds
    s_add_u32 m0, s99, 143360
    s_add_u32 s64, s64, 16384
    buffer_load_dwordx4 v145, s[20:23], s64 offen lds
    s_waitcnt vmcnt(18)
    ds_read_b128 v[56:59], v99 offset:28672
    ds_read_b128 v[60:63], v98 offset:28672
    ds_read_b128 v[64:67], v97 offset:28672
    ds_read_b128 v[68:71], v96 offset:28672
    s_waitcnt vmcnt(4) lgkmcnt(0)
    s_mov_b32 s13, 0
    s_mov_b32 s16, 0
    s_add_u32 s17, s63, s16
    s_add_u32 s18, s13, s16
    s_add_u32 s19, s75, s16
    s_xor_b32 s12, s17, 8192
    s_xor_b32 s14, s18, 8192
    s_xor_b32 s15, s19, 8192
L_qc_3:
    v_max3_u32 v192, v184, v188, v230
    v_max3_u32 v192, v192, v232, v236
    v_cmp_eq_u32 vcc, -1, v192
    s_cbranch_vccnz L_rt_4
    buffer_store_dwordx4 v[136:139], v160, s[52:55], 0 offen sc1
    v_mov_b32 v196, 0
    v_mov_b32 v197, 0
    v_mov_b32 v198, 0
    v_mov_b32 v199, 0
    s_nop 1
    v_smfmac_f32_16x16x64_bf16 v[196:199], v[232:235], v[56:63], v7
    v_smfmac_f32_16x16x64_bf16 v[196:199], v[236:239], v[64:71], v7
    s_nop 7
    v_add_f32 v196, v196, v197
    v_add_f32 v198, v198, v199
    v_add_f32 v200, v196, v198
    v_add_f32 v201, v196, v198
    buffer_store_dwordx4 v[152:155], v15, s[52:55], 0 offen sc1
    s_nop 0
    v_permlane16_swap_b32 v200, v201
    v_add_f32 v202, v200, v201
    v_add_f32 v203, v200, v201
    s_nop 1
    v_permlane32_swap_b32 v202, v203
    v_add_f32 v172, v202, v203
    v_mov_b32 v196, 0
    v_mov_b32 v197, 0
    v_mov_b32 v198, 0
    v_mov_b32 v199, 0
    buffer_load_dwordx4 v[240:243], v157, s[52:55], 0 offen sc1
    s_nop 0
    v_smfmac_f32_16x16x64_bf16 v[196:199], v[184:187], v[56:63], v7
    v_smfmac_f32_16x16x64_bf16 v[196:199], v[188:191], v[64:71], v7
    v_add_f32_dpp v229, v231, v231 quad_perm:[1,0,3,2] row_mask:0xf bank_mask:0xf
    v_add_f32_dpp v228, v230, v230 quad_perm:[1,0,3,2] row_mask:0xf bank_mask:0xf
    s_nop 0
    v_add_f32_dpp v229, v229, v229 quad_perm:[2,3,0,1] row_mask:0xf bank_mask:0xf
    v_add_f32_dpp v228, v228, v228 quad_perm:[2,3,0,1] row_mask:0xf bank_mask:0xf
    s_nop 0
    v_add_f32_dpp v229, v229, v229 row_half_mirror row_mask:0xf bank_mask:0xf
    v_add_f32_dpp v228, v228, v228 row_half_mirror row_mask:0xf bank_mask:0xf
    v_mul_f32 v229, 0x3acccccd, v229
    v_mul_f32 v228, 0x3acccccd, v228
    v_fma_f32 v228, -v229, v229, v228
    v_max_f32 v228, 0, v228
    v_add_f32 v228, 0x3727c5ac, v228
    v_rsq_f32 v228, v228
    s_nop 0
    v_mul_f32 v228, 0x3e0293ee, v228
    v_add_f32 v196, v196, v197
    v_add_f32 v198, v198, v199
    v_add_f32 v200, v196, v198
    v_add_f32 v201, v196, v198
    s_nop 1
    v_permlane16_swap_b32 v200, v201
    v_add_f32 v202, v200, v201
    v_add_f32 v203, v200, v201
    s_nop 1
    v_permlane32_swap_b32 v202, v203
    v_add_f32 v198, v202, v203
    v_fma_f32 v198, -v229, v172, v198
    v_mul_f32 v198, v198, v228
    v_cvt_pk_bf16_f32 v198, v198, v198
    v_min_u32 v198, -2, v198
    ds_write_b16 v162, v198
    v_lshlrev_b32 v199, 4, v2
    s_waitcnt lgkmcnt(0)
    s_barrier
    v_add_u32 v199, 155648, v199
    ds_read_b128 v[200:203], v199
    s_waitcnt lgkmcnt(0)
    buffer_store_dwordx4 v[200:203], v21, s[52:55], s63 offen sc1
    s_add_u32 m0, s62, 4096
    s_xor_b32 s76, s85, 16384
    buffer_load_dwordx4 v89, s[8:11], s76 offen lds
    s_add_u32 m0, s62, 5120
    s_xor_b32 s76, s85, 20480
    buffer_load_dwordx4 v88, s[8:11], s76 offen lds
    s_add_u32 m0, s62, 6144
    s_xor_b32 s76, s85, 24576
    buffer_load_dwordx4 v91, s[8:11], s76 offen lds
    s_add_u32 m0, s62, 7168
    s_xor_b32 s76, s85, 28672
    buffer_load_dwordx4 v90, s[8:11], s76 offen lds
    s_add_u32 m0, s62, 8192
    s_xor_b32 s76, s85, 32768
    buffer_load_dwordx4 v90, s[8:11], s76 offen lds
    s_add_u32 m0, s62, 9216
    s_xor_b32 s76, s85, 36864
    buffer_load_dwordx4 v91, s[8:11], s76 offen lds
    s_add_u32 m0, s62, 10240
    s_xor_b32 s76, s85, 40960
    buffer_load_dwordx4 v88, s[8:11], s76 offen lds
    s_add_u32 m0, s62, 11264
    s_xor_b32 s76, s85, 45056
    buffer_load_dwordx4 v89, s[8:11], s76 offen lds
    s_add_u32 m0, s62, 12288
    s_xor_b32 s76, s85, 49152
    buffer_load_dwordx4 v91, s[8:11], s76 offen lds
    s_add_u32 m0, s62, 13312
    s_xor_b32 s76, s85, 53248
    buffer_load_dwordx4 v90, s[8:11], s76 offen lds
    s_add_u32 m0, s62, 14336
    s_xor_b32 s76, s85, 57344
    buffer_load_dwordx4 v89, s[8:11], s76 offen lds
    s_add_u32 m0, s62, 15360
    s_xor_b32 s76, s85, 61440
    buffer_load_dwordx4 v88, s[8:11], s76 offen lds
    s_add_u32 m0, s62, 16384
    s_xor_b32 s76, s85, 65536
    buffer_load_dwordx4 v88, s[8:11], s76 offen lds
    s_add_u32 m0, s62, 17408
    s_xor_b32 s76, s85, 69632
    buffer_load_dwordx4 v89, s[8:11], s76 offen lds
    s_add_u32 m0, s62, 18432
    s_xor_b32 s76, s85, 73728
    buffer_load_dwordx4 v90, s[8:11], s76 offen lds
    s_add_u32 m0, s62, 19456
    s_xor_b32 s76, s85, 77824
    buffer_load_dwordx4 v91, s[8:11], s76 offen lds
    s_add_u32 m0, s62, 20480
    s_xor_b32 s76, s85, 81920
    buffer_load_dwordx4 v89, s[8:11], s76 offen lds
    s_add_u32 m0, s62, 21504
    s_xor_b32 s76, s85, 86016
    buffer_load_dwordx4 v88, s[8:11], s76 offen lds
    s_add_u32 m0, s62, 22528
    s_xor_b32 s76, s85, 90112
    buffer_load_dwordx4 v91, s[8:11], s76 offen lds
    s_add_u32 m0, s62, 23552
    s_xor_b32 s76, s85, 94208
    buffer_load_dwordx4 v90, s[8:11], s76 offen lds
    s_waitcnt vmcnt(8)
    s_add_u32 m0, s62, 24576
    s_xor_b32 s76, s85, 98304
    buffer_load_dwordx4 v90, s[8:11], s76 offen lds
    ds_read_b128 a[0:3], v96 offset:0
    ds_read_b128 a[4:7], v97 offset:0
    ds_read_b128 a[8:11], v98 offset:0
    ds_read_b128 a[12:15], v99 offset:0
    ds_read_b128 a[16:19], v97 offset:4096
    ds_read_b128 a[20:23], v96 offset:4096
    ds_read_b128 a[24:27], v99 offset:4096
    s_add_u32 m0, s62, 25600
    s_xor_b32 s76, s85, 102400
    buffer_load_dwordx4 v91, s[8:11], s76 offen lds
    ds_read_b128 a[28:31], v98 offset:4096
    ds_read_b128 a[32:35], v98 offset:8192
    ds_read_b128 a[36:39], v99 offset:8192
    ds_read_b128 a[40:43], v96 offset:8192
    ds_read_b128 a[44:47], v97 offset:8192
    ds_read_b128 a[48:51], v99 offset:12288
    s_add_u32 m0, s62, 26624
    s_xor_b32 s76, s85, 106496
    buffer_load_dwordx4 v88, s[8:11], s76 offen lds
    ds_read_b128 a[52:55], v98 offset:12288
    ds_read_b128 a[56:59], v97 offset:12288
    ds_read_b128 a[60:63], v96 offset:12288
    ds_read_b64_tr_b16 a[128:129], v100 offset:0
    ds_read_b64_tr_b16 a[132:133], v102 offset:1024
    ds_read_b64_tr_b16 a[136:137], v104 offset:2048
    s_add_u32 m0, s62, 27648
    s_xor_b32 s76, s85, 110592
    buffer_load_dwordx4 v89, s[8:11], s76 offen lds
    ds_read_b64_tr_b16 a[140:141], v106 offset:3072
    ds_read_b64_tr_b16 a[144:145], v101 offset:0
    ds_read_b64_tr_b16 a[148:149], v103 offset:1024
    ds_read_b64_tr_b16 a[152:153], v105 offset:2048
    ds_read_b64_tr_b16 a[156:157], v107 offset:3072
    ds_read_b64_tr_b16 a[160:161], v102 offset:0
    s_add_u32 m0, s62, 28672
    s_xor_b32 s76, s85, 114688
    buffer_load_dwordx4 v91, s[8:11], s76 offen lds
    ds_read_b64_tr_b16 a[164:165], v100 offset:1024
    ds_read_b64_tr_b16 a[168:169], v106 offset:2048
    ds_read_b64_tr_b16 a[172:173], v104 offset:3072
    ds_read_b64_tr_b16 a[176:177], v103 offset:0
    ds_read_b64_tr_b16 a[180:181], v101 offset:1024
    ds_read_b64_tr_b16 a[184:185], v107 offset:2048
    s_add_u32 m0, s62, 29696
    s_xor_b32 s76, s85, 118784
    buffer_load_dwordx4 v90, s[8:11], s76 offen lds
    ds_read_b64_tr_b16 a[188:189], v105 offset:3072
    ds_read_b64_tr_b16 a[192:193], v104 offset:0
    ds_read_b64_tr_b16 a[196:197], v106 offset:1024
    ds_read_b64_tr_b16 a[200:201], v100 offset:2048
    ds_read_b64_tr_b16 a[204:205], v102 offset:3072
    ds_read_b64_tr_b16 a[208:209], v105 offset:0
    s_add_u32 m0, s62, 30720
    s_xor_b32 s76, s85, 122880
    buffer_load_dwordx4 v89, s[8:11], s76 offen lds
    ds_read_b64_tr_b16 a[212:213], v107 offset:1024
    ds_read_b64_tr_b16 a[216:217], v101 offset:2048
    ds_read_b64_tr_b16 a[220:221], v103 offset:3072
    ds_read_b64_tr_b16 a[224:225], v106 offset:0
    ds_read_b64_tr_b16 a[228:229], v104 offset:1024
    ds_read_b64_tr_b16 a[232:233], v102 offset:2048
    s_add_u32 m0, s62, 31744
    s_xor_b32 s76, s85, 126976
    buffer_load_dwordx4 v88, s[8:11], s76 offen lds
    ds_read_b64_tr_b16 a[236:237], v100 offset:3072
    ds_read_b64_tr_b16 a[240:241], v107 offset:0
    ds_read_b64_tr_b16 a[244:245], v105 offset:1024
    ds_read_b64_tr_b16 a[248:249], v103 offset:2048
    ds_read_b64_tr_b16 a[252:253], v101 offset:3072
    s_waitcnt lgkmcnt(0)
    s_waitcnt vmcnt(29)
L_fl_5:
    v_mov_b32 v194, s101
    v_subrev_co_u32 v192, vcc, s100, v240
    s_nop 1
    v_subb_co_u32 v193, vcc, v241, v194, vcc
    v_lshrrev_b32 v192, 24, v192
    v_or_b32 v192, v192, v193
    v_cmp_ne_u32 vcc, 0, v192
    s_and_b32 s66, vcc_lo, 0xffff
    s_cbranch_scc1 L_rt_6
    buffer_load_dwordx4 v[244:247], v14, s[52:55], s17 offen offset:0 sc1
    buffer_load_dwordx4 v[248:251], v14, s[52:55], s17 offen offset:128 sc1
    s_waitcnt vmcnt(32)
    s_barrier
    s_memrealtime s[88:89]
    s_mov_b32 s48, 32768
    s_add_u32 s49, s49, 32768
    s_waitcnt lgkmcnt(0)
    v_mov_b32 v132, s88
    v_mov_b32 v133, s89
    v_mov_b32 v134, s88
    v_or_b32 v135, s72, v133
    buffer_store_dwordx4 v[132:135], v169, s[52:55], s49 offen sc1
    s_cmp_lt_u32 s58, 2
    s_cselect_b32 s66, 0, 536870912
    buffer_load_dword v149, v160, s[52:55], s66 offen sc1
    s_xor_b32 s73, s94, 0
    s_mul_i32 s64, s73, 20480
    s_lshl_b32 s73, s73, 10
    s_add_u32 m0, s73, s62
    s_add_u32 s64, s64, s68
    buffer_load_dwordx4 v164, s[24:27], s64 offen lds
    s_xor_b32 s73, s94, 1
    s_mul_i32 s64, s73, 20480
    s_lshl_b32 s73, s73, 10
    s_add_u32 m0, s73, s62
    s_add_u32 s64, s64, s68
    buffer_load_dwordx4 v164, s[24:27], s64 offen lds
    s_waitcnt vmcnt(6)
    s_xor_b32 s73, s94, 2
    s_mul_i32 s64, s73, 20480
    s_lshl_b32 s73, s73, 10
    s_add_u32 m0, s73, s62
    s_add_u32 s64, s64, s68
    buffer_load_dwordx4 v164, s[24:27], s64 offen lds
    ds_read_b128 a[64:67], v96 offset:16384
    ds_read_b128 a[68:71], v97 offset:16384
    ds_read_b128 a[72:75], v98 offset:16384
    ds_read_b128 a[76:79], v99 offset:16384
    s_xor_b32 s73, s94, 3
    s_mul_i32 s64, s73, 20480
    s_lshl_b32 s73, s73, 10
    s_add_u32 m0, s73, s62
    s_add_u32 s64, s64, s68
    buffer_load_dwordx4 v164, s[24:27], s64 offen lds
    ds_read_b128 a[80:83], v97 offset:20480
    ds_read_b128 a[84:87], v96 offset:20480
    ds_read_b128 a[88:91], v99 offset:20480
    buffer_load_ushort v27, v147, s[40:43], s86 offen
    ds_read_b128 a[92:95], v98 offset:20480
    ds_read_b128 a[96:99], v98 offset:24576
    ds_read_b128 a[100:103], v99 offset:24576
    ds_read_b128 a[104:107], v96 offset:24576
    buffer_load_ushort v26, v146, s[32:35], 0 offen
    ds_read_b128 a[108:111], v97 offset:24576
    ds_read_b128 a[112:115], v99 offset:28672
    ds_read_b128 a[116:119], v98 offset:28672
    buffer_load_ushort v29, v147, s[4:7], s86 offen
    ds_read_b128 a[120:123], v97 offset:28672
    ds_read_b128 a[124:127], v96 offset:28672
    s_waitcnt lgkmcnt(0)
    v_mov_b32 v212, 0
    v_mov_b32 v213, 0
    v_mov_b32 v216, 0
    v_mov_b32 v217, 0
    v_mov_b32 v220, 0
    v_mov_b32 v221, 0
    v_mov_b32 v224, 0
    v_mov_b32 v225, 0
    v_mov_b32 v228, 0
    v_mov_b32 v229, 0
    v_mov_b32 v232, 0
    v_mov_b32 v233, 0
    v_mov_b32 v236, 0
    v_mov_b32 v237, 0
    v_mov_b32 v240, 0
    v_mov_b32 v241, 0
    s_waitcnt vmcnt(9)
L_top_7:
    v_max_u32 v196, v244, v248
    v_cmp_eq_u32 vcc, -1, v196
    s_cbranch_vccnz L_rt_8
    v_smfmac_f32_16x16x64_bf16 v[212:215], v[244:247], a[0:7], v7
    s_xor_b32 s73, s94, 4
    s_mul_i32 s64, s73, 20480
    s_lshl_b32 s73, s73, 10
    s_add_u32 m0, s73, s62
    s_add_u32 s64, s64, s68
    buffer_load_dwordx4 v164, s[24:27], s64 offen lds
    ds_read_b64_tr_b16 a[130:131], v100 offset:16384
    ds_read_b64_tr_b16 a[134:135], v102 offset:17408
    v_smfmac_f32_16x16x64_bf16 v[212:215], v[248:251], a[8:15], v7
    ds_read_b64_tr_b16 a[138:139], v104 offset:18432
    ds_read_b64_tr_b16 a[142:143], v106 offset:19456
    v_xor_b32 v197, 16, v10
    v_smfmac_f32_16x16x64_bf16 v[216:219], v[244:247], a[16:23], v7
    ds_read_b64_tr_b16 a[146:147], v101 offset:16384
    s_xor_b32 s73, s94, 5
    s_mul_i32 s64, s73, 20480
    s_lshl_b32 s73, s73, 10
    s_add_u32 m0, s73, s62
    s_add_u32 s64, s64, s68
    buffer_load_dwordx4 v164, s[24:27], s64 offen lds
    ds_read_b64_tr_b16 a[150:151], v103 offset:17408
    v_smfmac_f32_16x16x64_bf16 v[216:219], v[248:251], a[24:31], v7
    ds_read_b64_tr_b16 a[154:155], v105 offset:18432
    ds_read_b64_tr_b16 a[158:159], v107 offset:19456
    v_xor_b32 v252, 16, v11
    v_smfmac_f32_16x16x64_bf16 v[220:223], v[244:247], a[64:71], v7
    ds_read_b64_tr_b16 a[162:163], v102 offset:16384
    ds_read_b64_tr_b16 a[166:167], v100 offset:17408
    s_xor_b32 s73, s94, 6
    s_mul_i32 s64, s73, 20480
    s_lshl_b32 s73, s73, 10
    s_add_u32 m0, s73, s62
    s_add_u32 s64, s64, s68
    buffer_load_dwordx4 v164, s[24:27], s64 offen lds
    v_smfmac_f32_16x16x64_bf16 v[220:223], v[248:251], a[72:79], v7
    ds_read_b64_tr_b16 a[170:171], v106 offset:18432
    ds_read_b64_tr_b16 a[174:175], v104 offset:19456
    v_smfmac_f32_16x16x64_bf16 v[224:227], v[244:247], a[80:87], v7
    ds_read_b64_tr_b16 a[178:179], v103 offset:16384
    ds_read_b64_tr_b16 a[182:183], v101 offset:17408
    v_smfmac_f32_16x16x64_bf16 v[224:227], v[248:251], a[88:95], v7
    ds_read_b64_tr_b16 a[186:187], v107 offset:18432
    s_xor_b32 s73, s94, 7
    s_mul_i32 s64, s73, 20480
    s_lshl_b32 s73, s73, 10
    s_add_u32 m0, s73, s62
    s_add_u32 s64, s64, s68
    buffer_load_dwordx4 v164, s[24:27], s64 offen lds
    ds_read_b64_tr_b16 a[190:191], v105 offset:19456
    v_smfmac_f32_16x16x64_bf16 v[228:231], v[244:247], a[32:39], v7
    ds_read_b64_tr_b16 a[194:195], v104 offset:16384
    ds_read_b64_tr_b16 a[198:199], v106 offset:17408
    v_smfmac_f32_16x16x64_bf16 v[228:231], v[248:251], a[40:47], v7
    ds_read_b64_tr_b16 a[202:203], v100 offset:18432
    ds_read_b64_tr_b16 a[206:207], v102 offset:19456
    s_mov_b32 s64, s95
    s_add_u32 m0, s62, 8192
    s_nop 0
    buffer_load_dwordx4 v165, s[28:31], s64 offen lds
    v_add_f32 v180, v212, v213
    v_smfmac_f32_16x16x64_bf16 v[232:235], v[244:247], a[48:55], v7
    ds_read_b64_tr_b16 a[210:211], v105 offset:16384
    ds_read_b64_tr_b16 a[214:215], v107 offset:17408
    v_smfmac_f32_16x16x64_bf16 v[232:235], v[248:251], a[56:63], v7
    ds_read_b64_tr_b16 a[218:219], v101 offset:18432
    ds_read_b64_tr_b16 a[222:223], v103 offset:19456
    v_add_f32 v181, v216, v217
    s_add_u32 m0, s62, 9216
    s_add_u32 s64, s64, 13824
    buffer_load_dwordx4 v165, s[28:31], s64 offen lds
    v_smfmac_f32_16x16x64_bf16 v[236:239], v[244:247], a[96:103], v7
    ds_read_b64_tr_b16 a[226:227], v106 offset:16384
    ds_read_b64_tr_b16 a[230:231], v104 offset:17408
    v_smfmac_f32_16x16x64_bf16 v[236:239], v[248:251], a[104:111], v7
    ds_read_b64_tr_b16 a[234:235], v102 offset:18432
    ds_read_b64_tr_b16 a[238:239], v100 offset:19456
    v_add_f32 v182, v220, v221
    v_smfmac_f32_16x16x64_bf16 v[240:243], v[244:247], a[112:119], v7
    s_add_u32 s64, s64, 13824
    s_add_u32 m0, s62, 10240
    s_nop 0
    buffer_load_dwordx4 v163, s[28:31], s64 offen lds
    ds_read_b64_tr_b16 a[242:243], v107 offset:16384
    ds_read_b64_tr_b16 a[246:247], v105 offset:17408
    v_smfmac_f32_16x16x64_bf16 v[240:243], v[248:251], a[120:127], v7
    ds_read_b64_tr_b16 a[250:251], v103 offset:18432
    ds_read_b64_tr_b16 a[254:255], v101 offset:19456
    v_add_f32 v183, v224, v225
    ds_write_b128 v10, v[180:183]
    v_add_f32 v184, v228, v229
    v_add_f32 v185, v232, v233
    v_add_f32 v186, v236, v237
    s_nop 0
    v_add_f32 v187, v240, v241
    ds_write_b128 v197, v[184:187] offset:1024
    s_waitcnt vmcnt(50) lgkmcnt(0)
    s_barrier
    ds_read_b128 v[180:183], v11 offset:0
    ds_read_b128 v[188:191], v11 offset:2048
    ds_read_b128 v[196:199], v11 offset:4096
    ds_read_b128 v[204:207], v11 offset:6144
    ds_read_b128 v[184:187], v252 offset:0
    ds_read_b128 v[192:195], v252 offset:2048
    ds_read_b128 v[200:203], v252 offset:4096
    ds_read_b128 v[208:211], v252 offset:6144
    v_mov_b32 v212, 0
    v_mov_b32 v213, 0
    v_mov_b32 v216, 0
    v_mov_b32 v217, 0
    v_mov_b32 v220, 0
    v_mov_b32 v221, 0
    v_mov_b32 v224, 0
    v_mov_b32 v225, 0
    v_mov_b32 v228, 0
    v_mov_b32 v229, 0
    v_mov_b32 v232, 0
    v_mov_b32 v233, 0
    v_mov_b32 v236, 0
    v_mov_b32 v237, 0
    v_mov_b32 v240, 0
    v_mov_b32 v241, 0
    s_waitcnt lgkmcnt(6)
    v_pk_add_f32 v[180:181], v[180:181], v[188:189]
    v_pk_add_f32 v[182:183], v[182:183], v[190:191]
    s_waitcnt lgkmcnt(4)
    v_pk_add_f32 v[196:197], v[196:197], v[204:205]
    v_pk_add_f32 v[198:199], v[198:199], v[206:207]
    v_pk_add_f32 v[180:181], v[180:181], v[196:197]
    v_pk_add_f32 v[182:183], v[182:183], v[198:199]
    v_max3_f32 v252, v180, v181, v182
    s_waitcnt lgkmcnt(2)
    v_pk_add_f32 v[184:185], v[184:185], v[192:193]
    v_pk_add_f32 v[186:187], v[186:187], v[194:195]
    s_waitcnt lgkmcnt(0)
    v_pk_add_f32 v[200:201], v[200:201], v[208:209]
    v_pk_add_f32 v[202:203], v[202:203], v[210:211]
    v_pk_add_f32 v[184:185], v[184:185], v[200:201]
    v_pk_add_f32 v[186:187], v[186:187], v[202:203]
    v_max3_f32 v253, v183, v184, v185
    v_max3_f32 v252, v252, v186, v187
    v_max_f32 v252, v252, v253
    v_mov_b32 v200, 0x3f803f80
    v_mov_b32 v201, 0x3f803f80
    v_max_f32_dpp v252, v252, v252 quad_perm:[1,0,3,2] row_mask:0xf bank_mask:0xf
    v_mov_b32 v202, 0x3f803f80
    v_mov_b32 v203, 0x3f803f80
    v_max_f32_dpp v253, v252, v252 quad_perm:[2,3,0,1] row_mask:0xf bank_mask:0xf
    v_max_f32_dpp v252, v252, v252 quad_perm:[2,3,0,1] row_mask:0xf bank_mask:0xf
    v_mov_b32 v204, 0x3f803f80
    v_mov_b32 v205, 0x3f803f80
    v_permlane16_swap_b32 v252, v253
    v_max_f32 v196, v252, v253
    v_max_f32 v197, v252, v253
    v_mov_b32 v206, 0x3f803f80
    v_mov_b32 v207, 0x3f803f80
    v_permlane32_swap_b32 v196, v197
    v_max_f32 v198, v196, v197
    v_pk_add_f32 v[180:181], v[180:181], v[198:199] op_sel_hi:[1,0] neg_lo:[0,1] neg_hi:[0,1]
    v_pk_add_f32 v[182:183], v[182:183], v[198:199] op_sel_hi:[1,0] neg_lo:[0,1] neg_hi:[0,1]
    v_pk_add_f32 v[184:185], v[184:185], v[198:199] op_sel_hi:[1,0] neg_lo:[0,1] neg_hi:[0,1]
    v_pk_add_f32 v[186:187], v[186:187], v[198:199] op_sel_hi:[1,0] neg_lo:[0,1] neg_hi:[0,1]
    v_exp_f32 v180, v180
    v_exp_f32 v181, v181
    v_exp_f32 v182, v182
    v_exp_f32 v183, v183
    v_exp_f32 v184, v184
    v_exp_f32 v185, v185
    v_exp_f32 v186, v186
    v_exp_f32 v187, v187
    v_cvt_pk_bf16_f32 v244, v180, v181
    v_cvt_pk_bf16_f32 v245, v182, v183
    v_cvt_pk_bf16_f32 v246, v184, v185
    v_cvt_pk_bf16_f32 v247, v186, v187
    s_nop 1
    v_smfmac_f32_16x16x64_bf16 v[212:215], v[244:247], a[128:135], v7
    v_mov_b32_dpp v248, v244 quad_perm:[2,3,2,3] row_mask:0xf bank_mask:0xf
    v_mov_b32_dpp v249, v245 quad_perm:[2,3,2,3] row_mask:0xf bank_mask:0xf
    v_smfmac_f32_16x16x64_bf16 v[216:219], v[244:247], a[144:151], v7
    v_mov_b32_dpp v250, v246 quad_perm:[2,3,2,3] row_mask:0xf bank_mask:0xf
    v_mov_b32_dpp v251, v247 quad_perm:[2,3,2,3] row_mask:0xf bank_mask:0xf
    v_smfmac_f32_16x16x64_bf16 v[220:223], v[244:247], a[160:167], v7
    v_mov_b32 v192, 0
    v_mov_b32 v193, 0
    v_smfmac_f32_16x16x64_bf16 v[224:227], v[244:247], a[176:183], v7
    v_min_u32 v198, -2, v198
    v_smfmac_f32_16x16x64_bf16 v[192:195], v[244:247], v[200:207], v7
    v_smfmac_f32_16x16x64_bf16 v[192:195], v[248:251], v[200:207], v7
    v_smfmac_f32_16x16x64_bf16 v[228:231], v[244:247], a[192:199], v7
    v_smfmac_f32_16x16x64_bf16 v[232:235], v[244:247], a[208:215], v7
    v_smfmac_f32_16x16x64_bf16 v[236:239], v[244:247], a[224:231], v7
    v_smfmac_f32_16x16x64_bf16 v[240:243], v[244:247], a[240:247], v7
    v_smfmac_f32_16x16x64_bf16 v[212:215], v[248:251], a[136:143], v7
    v_smfmac_f32_16x16x64_bf16 v[216:219], v[248:251], a[152:159], v7
    v_smfmac_f32_16x16x64_bf16 v[220:223], v[248:251], a[168:175], v7
    v_smfmac_f32_16x16x64_bf16 v[224:227], v[248:251], a[184:191], v7
    v_add_f32 v199, v192, v193
    buffer_store_dwordx2 v[198:199], v16, s[52:55], s63 offen sc1
    v_smfmac_f32_16x16x64_bf16 v[228:231], v[248:251], a[200:207], v7
    buffer_load_dwordx4 v[112:115], v158, s[52:55], 0 offen sc1
    v_smfmac_f32_16x16x64_bf16 v[232:235], v[248:251], a[216:223], v7
    v_add_f32 v212, v212, v213
    v_smfmac_f32_16x16x64_bf16 v[236:239], v[248:251], a[232:239], v7
    v_add_f32 v216, v216, v217
    v_cvt_pk_bf16_f32 v208, v212, v216
    v_smfmac_f32_16x16x64_bf16 v[240:243], v[248:251], a[248:255], v7
    v_add_f32 v220, v220, v221
    v_add_f32 v224, v224, v225
    v_cvt_pk_bf16_f32 v209, v220, v224
    v_add_f32 v228, v228, v229
    v_add_f32 v232, v232, v233
    v_cvt_pk_bf16_f32 v210, v228, v232
    v_add_f32 v236, v236, v237
    s_nop 0
    v_add_f32 v240, v240, v241
    v_cvt_pk_bf16_f32 v211, v236, v240
    v_min_u32 v208, -2, v208
    buffer_store_dwordx4 v[208:211], v15, s[52:55], s13 offen sc1
    s_lshr_b32 s73, s94, 1
    s_xor_b32 s73, s73, 0
    s_mul_i32 s64, s73, 20480
    s_lshl_b32 s73, s73, 10
    s_add_u32 s73, s73, 12288
    s_add_u32 m0, s73, s62
    s_add_u32 s64, s64, s92
    buffer_load_dwordx4 v164, s[36:39], s64 offen lds
    s_lshr_b32 s73, s94, 1
    s_xor_b32 s73, s73, 1
    s_mul_i32 s64, s73, 20480
    s_lshl_b32 s73, s73, 10
    s_add_u32 s73, s73, 12288
    s_add_u32 m0, s73, s62
    s_add_u32 s64, s64, s92
    buffer_load_dwordx4 v164, s[36:39], s64 offen lds
    s_lshr_b32 s73, s94, 1
    s_xor_b32 s73, s73, 2
    s_mul_i32 s64, s73, 20480
    s_lshl_b32 s73, s73, 10
    s_add_u32 s73, s73, 12288
    s_add_u32 m0, s73, s62
    s_add_u32 s64, s64, s92
    buffer_load_dwordx4 v164, s[36:39], s64 offen lds
    s_lshr_b32 s73, s94, 1
    s_xor_b32 s73, s73, 3
    s_mul_i32 s64, s73, 20480
    s_lshl_b32 s73, s73, 10
    s_add_u32 s73, s73, 12288
    s_add_u32 m0, s73, s62
    s_add_u32 s64, s64, s92
    buffer_load_dwordx4 v164, s[36:39], s64 offen lds
    s_waitcnt vmcnt(5)
L_fl_9:
    v_mov_b32 v194, s101
    v_subrev_co_u32 v192, vcc, s100, v112
    s_nop 1
    v_subb_co_u32 v193, vcc, v113, v194, vcc
    v_lshrrev_b32 v192, 24, v192
    v_or_b32 v192, v192, v193
    v_cmp_ne_u32 vcc, 0, v192
    s_and_b32 s66, vcc_lo, -1
    s_cbranch_scc1 L_rt_10
    v_and_b32 v115, 0xf0000000, v115
    v_cmp_ne_u32 vcc, s72, v115
    s_lshl_b32 s67, s58, 2
    s_add_u32 s67, s67, 157824
    s_and_b32 s66, vcc_lo, 0xff00
    v_mov_b32 v204, s67
    v_mov_b32 v205, s66
    ds_write_b32 v204, v205
    s_waitcnt vmcnt(4)
    buffer_load_dwordx2 v[228:229], v18, s[52:55], s17 offen sc1
    buffer_load_dwordx4 v[188:191], v17, s[52:55], s18 offen sc1
    ds_read_b64_tr_b16 v[72:73], v177 offset:0
    ds_read_b64_tr_b16 v[74:75], v177 offset:1024
    ds_read_b64_tr_b16 v[76:77], v178 offset:0
    ds_read_b64_tr_b16 v[78:79], v178 offset:1024
    ds_read_b64_tr_b16 v[80:81], v177 offset:8192
    ds_read_b64_tr_b16 v[82:83], v177 offset:9216
    ds_read_b64_tr_b16 v[84:85], v178 offset:8192
    ds_read_b64_tr_b16 v[86:87], v178 offset:9216
    v_lshrrev_b32 v192, 2, v2
    v_and_b32 v193, 3, v2
    v_lshlrev_b32 v193, 3, v193
    v_lshl_add_u32 v161, v192, 7, v193
    v_lshl_add_u32 v161, v3, 15, v161
    s_lshl_b32 s66, s58, 5
    v_add_u32 v161, s66, v161
    v_lshl_add_u32 v192, v3, 3, v192
    v_lshl_add_u32 v192, v192, 6, v193
    v_and_b32 v193, 1, v3
    v_lshl_add_u32 v192, v193, 5, v192
    v_add_u32 v148, s62, v192
    v_xor_b32 v159, 32, v148
    s_and_b32 s66, s66, 32
    v_xor_b32 v177, s66, v192
    v_add_u32 v178, 65536, v177
    s_waitcnt vmcnt(16)
    v_lshlrev_b32 v26, 16, v26
    v_lshlrev_b32 v27, 16, v27
    v_lshlrev_b32 v29, 16, v29
    v_and_b32 v27, s74, v27
    v_and_b32 v29, s74, v29
    s_and_b32 s8, s74, 0x8000
    s_and_b32 s9, s74, 0x80008000
    s_cmp_eq_u32 s58, 0
    s_cselect_b32 s9, s9, 0
    s_andn2_b32 s74, 536870912, s74
    s_waitcnt vmcnt(12)
    ds_read_b64_tr_b16 v[88:89], v148 offset:0
    ds_read_b64_tr_b16 v[90:91], v148 offset:256
    ds_read_b64_tr_b16 v[104:105], v159 offset:0
    ds_read_b64_tr_b16 v[106:107], v159 offset:256
    ds_read_b64_tr_b16 v[92:93], v148 offset:2048
    ds_read_b64_tr_b16 v[94:95], v148 offset:2304
    ds_read_b64_tr_b16 v[108:109], v159 offset:2048
    ds_read_b64_tr_b16 v[110:111], v159 offset:2304
    ds_read_b64_tr_b16 v[96:97], v148 offset:4096
    ds_read_b64_tr_b16 v[98:99], v148 offset:4352
    ds_read_b64_tr_b16 v[112:113], v159 offset:4096
    ds_read_b64_tr_b16 v[114:115], v159 offset:4352
    ds_read_b64_tr_b16 v[100:101], v148 offset:6144
    ds_read_b64_tr_b16 v[102:103], v148 offset:6400
    ds_read_b64_tr_b16 v[116:117], v159 offset:6144
    ds_read_b64_tr_b16 v[118:119], v159 offset:6400
    v_xor_b32 v223, 64, v174
    s_waitcnt vmcnt(0)
L_h2_11:
    v_max_u32 v221, v188, v228
    v_cmp_eq_u32 vcc, -1, v221
    s_cbranch_vccnz L_rt_12
    ds_write_b64 v12, v[228:229]
    ds_write_b128 v173, v[188:191]
    s_waitcnt lgkmcnt(0)
    s_barrier
    ds_read_b64 v[228:229], v255
    ds_read_b128 v[188:191], v174 offset:0
    ds_read_b128 v[192:195], v223 offset:0
    ds_read_b128 v[196:199], v174 offset:2048
    ds_read_b128 v[200:203], v223 offset:2048
    s_waitcnt lgkmcnt(4)
    v_max_f32_dpp v221, v228, v228 quad_perm:[1,0,3,2] row_mask:0xf bank_mask:0xf
    s_waitcnt lgkmcnt(3)
    v_mfma_f32_16x16x32_bf16 v[204:207], v[188:191], v[72:75], 0
    v_max_f32_dpp v221, v221, v221 quad_perm:[2,3,0,1] row_mask:0xf bank_mask:0xf
    v_mfma_f32_16x16x32_bf16 v[208:211], v[188:191], v[76:79], 0
    s_waitcnt lgkmcnt(2)
    v_max_f32_dpp v222, v221, v221 row_half_mirror row_mask:0xf bank_mask:0xf
    v_max_f32_dpp v221, v221, v221 row_half_mirror row_mask:0xf bank_mask:0xf
    v_mfma_f32_16x16x32_bf16 v[204:207], v[192:195], v[80:83], v[204:207]
    v_mfma_f32_16x16x32_bf16 v[208:211], v[192:195], v[84:87], v[208:211]
    v_permlane16_swap_b32 v221, v222
    v_max_f32 v230, v221, v222
    v_max_f32 v231, v221, v222
    s_waitcnt lgkmcnt(1)
    v_mfma_f32_16x16x32_bf16 v[212:215], v[196:199], v[72:75], 0
    v_permlane32_swap_b32 v230, v231
    v_max_f32 v221, v230, v231
    v_mfma_f32_16x16x32_bf16 v[216:219], v[196:199], v[76:79], 0
    v_sub_f32 v220, v228, v221
    s_waitcnt lgkmcnt(0)
    v_mfma_f32_16x16x32_bf16 v[212:215], v[200:203], v[80:83], v[212:215]
    v_exp_f32 v220, v220
    v_mfma_f32_16x16x32_bf16 v[216:219], v[200:203], v[84:87], v[216:219]
    v_mul_f32 v229, v220, v229
    v_mov_b32 v232, 157824
    ds_read_b128 v[232:235], v232
    v_mul_f32_dpp v224, v220, v204 row_newbcast:0 row_mask:0xf bank_mask:0xf
    v_mul_f32_dpp v225, v220, v208 row_newbcast:0 row_mask:0xf bank_mask:0xf
    v_add_f32_dpp v221, v229, v229 quad_perm:[1,0,3,2] row_mask:0xf bank_mask:0xf
    v_mul_f32_dpp v226, v220, v205 row_newbcast:1 row_mask:0xf bank_mask:0xf
    v_mul_f32_dpp v227, v220, v209 row_newbcast:1 row_mask:0xf bank_mask:0xf
    v_add_f32_dpp v221, v221, v221 quad_perm:[2,3,0,1] row_mask:0xf bank_mask:0xf
    v_fmac_f32_dpp v224, v220, v206 row_newbcast:2 row_mask:0xf bank_mask:0xf
    v_fmac_f32_dpp v225, v220, v210 row_newbcast:2 row_mask:0xf bank_mask:0xf
    v_add_f32_dpp v222, v221, v221 row_half_mirror row_mask:0xf bank_mask:0xf
    v_add_f32_dpp v221, v221, v221 row_half_mirror row_mask:0xf bank_mask:0xf
    v_fmac_f32_dpp v226, v220, v207 row_newbcast:3 row_mask:0xf bank_mask:0xf
    v_fmac_f32_dpp v227, v220, v211 row_newbcast:3 row_mask:0xf bank_mask:0xf
    v_permlane16_swap_b32 v221, v222
    v_add_f32 v230, v221, v222
    v_add_f32 v231, v221, v222
    v_fmac_f32_dpp v224, v220, v212 row_newbcast:4 row_mask:0xf bank_mask:0xf
    v_fmac_f32_dpp v225, v220, v216 row_newbcast:4 row_mask:0xf bank_mask:0xf
    v_fmac_f32_dpp v226, v220, v213 row_newbcast:5 row_mask:0xf bank_mask:0xf
    v_fmac_f32_dpp v227, v220, v217 row_newbcast:5 row_mask:0xf bank_mask:0xf
    v_permlane32_swap_b32 v230, v231
    v_add_f32 v221, v230, v231
    v_fmac_f32_dpp v224, v220, v214 row_newbcast:6 row_mask:0xf bank_mask:0xf
    v_fmac_f32_dpp v225, v220, v218 row_newbcast:6 row_mask:0xf bank_mask:0xf
    v_rcp_f32 v221, v221
    v_fmac_f32_dpp v226, v220, v215 row_newbcast:7 row_mask:0xf bank_mask:0xf
    v_fmac_f32_dpp v227, v220, v219 row_newbcast:7 row_mask:0xf bank_mask:0xf
    v_add_f32 v224, v224, v226
    v_add_f32 v225, v225, v227
    s_waitcnt lgkmcnt(0)
    v_or3_b32 v232, v232, v233, v234
    v_or_b32 v232, v232, v235
    s_nop 0
    v_readfirstlane_b32 s66, v232
    s_cmp_eq_u32 s66, 0
    s_cselect_b32 s70, 0, 536870912
    s_cselect_b32 s84, 536870912, 0
    v_permlane32_swap_b32 v224, v225
    v_add_f32 v226, v224, v225
    v_add_f32 v227, v224, v225
    s_nop 1
    v_permlane16_swap_b32 v226, v227
    v_add_f32 v224, v226, v227
    v_mul_f32 v224, v224, v221
    s_nop 1
    v_mov_b32_dpp v225, v224 quad_perm:[1,0,3,2] row_mask:0xf bank_mask:0xf
    v_cvt_pk_bf16_f32 v224, v224, v225
    v_min_u32 v224, -2, v224
    buffer_store_dword v224, v19, s[52:55], s70 offen
    buffer_store_dword v224, v19, s[52:55], s84 offen sc1
    s_waitcnt vmcnt(0)
    s_memtime s[10:11]
    s_waitcnt lgkmcnt(0)
    buffer_load_dword v203, off, s[52:55], s93 sc1
    s_waitcnt vmcnt(0)
    s_memtime s[6:7]
    s_waitcnt lgkmcnt(0)
    s_sub_u32 s66, s6, s10
    s_cmp_lt_u32 s66, 530
    s_cselect_b32 s16, 8192, 0
    s_cselect_b32 s20, 0, -1
    s_cselect_b32 s21, -1, 0
    s_add_u32 s17, s63, s16
    s_add_u32 s18, s13, s16
    s_add_u32 s19, s75, s16
    s_xor_b32 s12, s17, 8192
    s_xor_b32 s14, s18, 8192
    s_xor_b32 s15, s19, 8192
L_p_13:
    buffer_load_dwordx4 v[188:191], v20, s[52:55], s63 offen offset:0 sc1
    buffer_load_dwordx4 v[192:195], v20, s[52:55], s63 offen offset:1024 sc1
    s_sub_u32 s69, s69, 1
    s_cbranch_scc1 L_sl_14
L_sb_15:
    v_mov_b32 v200, 0
    v_mov_b32 v201, 0
    v_mov_b32 v202, 0
    v_mov_b32 v203, 0
    v_mov_b32 v204, 0
    v_mov_b32 v205, 0
    v_mov_b32 v206, 0
    v_mov_b32 v207, 0
    s_waitcnt vmcnt(0)
    v_max_u32 v196, v188, v192
    v_cmp_eq_u32 vcc, -1, v196
    s_cbranch_vccnz L_p_13
    v_smfmac_f32_16x16x64_bf16 v[200:203], v[188:191], v[88:95], v7
    v_smfmac_f32_16x16x64_bf16 v[200:203], v[192:195], v[96:103], v7
    v_smfmac_f32_16x16x64_bf16 v[204:207], v[188:191], v[104:111], v7
    v_smfmac_f32_16x16x64_bf16 v[204:207], v[192:195], v[112:119], v7
    s_nop 5
    v_pk_add_f32 v[200:201], v[200:201], v[202:203]
    s_nop 0
    v_pk_add_f32 v[204:205], v[204:205], v[206:207]
    v_add_f32 v216, v200, v201
    v_add_f32 v217, v204, v205
    s_nop 1
    v_permlane32_swap_b32 v216, v217
    v_add_f32 v216, v216, v217
    ds_write_b32 v30, v216
    s_waitcnt lgkmcnt(0)
    s_barrier
    ds_read_b128 v[200:203], v31
    ds_read_b128 v[204:207], v31 offset:16
    s_waitcnt lgkmcnt(1)
    v_pk_add_f32 v[200:201], v[200:201], v[202:203]
    v_add_f32 v200, v200, v29
    s_waitcnt lgkmcnt(0)
    v_pk_add_f32 v[204:205], v[204:205], v[206:207]
    v_pk_add_f32 v[200:201], v[200:201], v[204:205]
    v_add_f32 v200, v200, v201
    v_cndmask_b32 v200, v28, v200, s[82:83]
    buffer_atomic_add_f32 v200, v22, s[52:55], s63 offen
    ds_read_b64_tr_b16 v[120:121], v161 offset:8192
    ds_read_b64_tr_b16 v[122:123], v161 offset:8704
    ds_read_b64_tr_b16 v[124:125], v161 offset:9216
    ds_read_b64_tr_b16 v[126:127], v161 offset:9728
    ds_read_b64_tr_b16 v[128:129], v161 offset:10240
    ds_read_b64_tr_b16 v[130:131], v161 offset:10752
    v_mov_b32 v184, v141
    v_mov_b32 v185, v141
    v_mov_b32 v186, v141
    v_mov_b32 v187, v141
    s_waitcnt lgkmcnt(0)
    ds_read_b64_tr_b16 v[132:133], v177 offset:12288
    ds_read_b64_tr_b16 v[134:135], v177 offset:12544
    ds_read_b64_tr_b16 v[136:137], v177 offset:14336
    ds_read_b64_tr_b16 v[138:139], v177 offset:14592
    ds_read_b64_tr_b16 v[140:141], v177 offset:45056
    ds_read_b64_tr_b16 v[142:143], v177 offset:45312
    ds_read_b64_tr_b16 v[144:145], v177 offset:47104
    ds_read_b64_tr_b16 v[146:147], v177 offset:47360
    ds_read_b64_tr_b16 v[148:149], v178 offset:12288
    ds_read_b64_tr_b16 v[150:151], v178 offset:12544
    ds_read_b64_tr_b16 v[152:153], v178 offset:14336
    ds_read_b64_tr_b16 v[154:155], v178 offset:14592
    ds_read_b64_tr_b16 v[156:157], v178 offset:45056
    ds_read_b64_tr_b16 v[158:159], v178 offset:45312
    ds_read_b64_tr_b16 v[160:161], v178 offset:47104
    ds_read_b64_tr_b16 v[162:163], v178 offset:47360
    v_mfma_f32_16x16x32_bf16 v[196:199], v[184:187], v[120:123], 0
    v_mfma_f32_16x16x32_bf16 v[196:199], v[184:187], v[124:127], v[196:199]
    v_mfma_f32_16x16x32_bf16 v[196:199], v[184:187], v[128:131], v[196:199]
    s_nop 7
    v_min_u32 v196, -2, v196
    v_add_u32 v197, s98, v24
    buffer_store_dword v196, v197, s[52:55], s70 offen
    buffer_store_dword v196, v197, s[52:55], s84 offen sc1
    s_add_u32 s90, s17, s74
    s_waitcnt vmcnt(0) lgkmcnt(0)
    s_barrier
L_p_16:
    buffer_load_dwordx4 v[184:187], v168, s[52:55], s17 offen sc1
    buffer_load_dwordx4 v[188:191], v168, s[52:55], s17 offen offset:64 sc1
    s_sub_u32 s69, s69, 1
    s_cbranch_scc1 L_sl_17
L_sb_18:
    s_waitcnt vmcnt(0)
    v_min_f32 v196, v187, v191
    v_cvt_pk_bf16_f32 v180, v184, v185
    v_cmp_neq_f32 vcc, 0x41000000, v196
    v_cvt_pk_bf16_f32 v181, v186, v187
    v_cvt_pk_bf16_f32 v182, v188, v189
    v_cvt_pk_bf16_f32 v183, v190, v191
    s_and_b64 vcc, vcc, s[78:79]
    s_cbranch_scc1 L_p_16
    v_mfma_f32_16x16x32_bf16 v[196:199], v[180:183], v[120:123], 0
    v_or_b32 v220, v180, v8
    v_or_b32 v221, v181, v8
    v_or_b32 v222, v182, v8
    v_or_b32 v223, v183, v8
    v_mfma_f32_16x16x32_bf16 v[200:203], v[180:183], v[124:127], 0
    v_mfma_f32_16x16x32_bf16 v[204:207], v[180:183], v[128:131], 0
    v_mfma_f32_16x16x32_bf16 v[224:227], v[180:183], v[220:223], 0
    s_nop 5
    v_add_f32 v196, v196, v201
    v_add_f32 v196, v196, v206
    v_add_f32 v229, v224, v225
    v_add_f32_dpp v228, v225, v224 quad_perm:[1,1,1,1] row_mask:0xf bank_mask:0xf
    v_add_f32 v229, v229, v226
    s_nop 0
    v_add_f32_dpp v228, v226, v228 quad_perm:[2,2,2,2] row_mask:0xf bank_mask:0xf
    v_cndmask_b32 v228, v228, v229, s[96:97]
    s_nop 1
    v_permlane32_swap_b32 v229, v228
    v_cndmask_b32 v196, v229, v196, s[80:81]
    v_min_u32 v196, -2, v196
    buffer_store_dword v196, v24, s[52:55], s70 offen
    buffer_store_dword v196, v24, s[52:55], s84 offen sc1
    s_waitcnt vmcnt(0)
L_p_19:
    buffer_load_dwordx4 v[200:203], v25, s[52:55], s98 offen offset:0 sc1
    buffer_load_dwordx4 v[204:207], v25, s[52:55], s98 offen offset:1024 sc1
    buffer_load_dwordx4 v[184:187], v25, s[52:55], s63 offen offset:0 sc1
    buffer_load_dwordx4 v[188:191], v25, s[52:55], s63 offen offset:1024 sc1
    buffer_load_dwordx2 v[230:231], v6, s[52:55], s63 offen offset:8 sc1
    s_sub_u32 s69, s69, 1
    s_cbranch_scc1 L_sl_20
L_sb_21:
    v_mov_b32 v194, 0xc0135761
    v_mov_b32 v224, 0
    v_mov_b32 v225, 0
    s_waitcnt vmcnt(0)
    v_max3_u32 v192, v184, v188, v230
    v_max3_u32 v192, v192, v200, v204
    v_cmp_eq_u32 vcc, -1, v192
    s_cbranch_vccnz L_p_19
    v_pk_add_f32 v[212:213], v[200:201], v[204:205]
    v_pk_add_f32 v[214:215], v[202:203], v[206:207]
    s_nop 0
    v_permlane32_swap_b32 v212, v213
    v_permlane32_swap_b32 v214, v215
    v_add_f32 v212, v212, v213
    v_add_f32 v214, v214, v215
    s_nop 1
    v_permlane16_swap_b32 v212, v214
    v_add_f32 v166, v212, v214
    v_mov_b32 v169, 1073741824
    buffer_load_dword v29, v179, s[52:55], s90 offen sc1
    v_add_f32_dpp v229, v231, v231 quad_perm:[1,0,3,2] row_mask:0xf bank_mask:0xf
    v_add_f32_dpp v228, v230, v230 quad_perm:[1,0,3,2] row_mask:0xf bank_mask:0xf
    v_pk_add_f32 v[212:213], v[184:185], v[188:189]
    v_pk_add_f32 v[214:215], v[186:187], v[190:191]
    v_add_f32_dpp v229, v229, v229 quad_perm:[2,3,0,1] row_mask:0xf bank_mask:0xf
    v_add_f32_dpp v228, v228, v228 quad_perm:[2,3,0,1] row_mask:0xf bank_mask:0xf
    v_permlane32_swap_b32 v212, v213
    v_permlane32_swap_b32 v214, v215
    v_add_f32_dpp v229, v229, v229 row_half_mirror row_mask:0xf bank_mask:0xf
    v_add_f32_dpp v228, v228, v228 row_half_mirror row_mask:0xf bank_mask:0xf
    v_add_f32 v212, v212, v213
    v_add_f32 v214, v214, v215
    v_mul_f32 v229, 0x3acccccd, v229
    v_mul_f32 v228, 0x3acccccd, v228
    v_permlane16_swap_b32 v212, v214
    v_fma_f32 v228, -v229, v229, v228
    v_add_f32 v192, v212, v214
    v_max_f32 v228, 0, v228
    v_add_f32 v228, 0x3727c5ac, v228
    v_rsq_f32 v228, v228
    v_fma_f32 v192, -v229, v166, v192
    v_fma_f32 v192, v192, v228, v26
    v_mul_f32 v193, v192, v192
    v_fmac_f32 v194, 0xbdd2d3e8, v193
    v_mul_f32 v193, v192, v194
    v_exp_f32 v193, v193
    s_nop 0
    v_add_f32 v193, 1.0, v193
    v_rcp_f32 v193, v193
    s_nop 0
    v_mul_f32 v192, v192, v193
    v_cvt_pk_bf16_f32 v192, v192, v192
    ds_write_b16 v9, v192
    s_cmp_ge_u32 s58, 2
    s_waitcnt lgkmcnt(0)
    s_barrier
    s_cbranch_scc1 L_f2s_22
    ds_read_b128 v[196:199], v254 offset:0
    ds_read_b128 v[200:203], v254 offset:128
    ds_read_b128 v[204:207], v254 offset:256
    ds_read_b128 v[208:211], v254 offset:384
    s_waitcnt lgkmcnt(3)
    v_smfmac_f32_16x16x64_bf16 v[224:227], v[196:199], v[132:139], v7
    s_waitcnt lgkmcnt(2)
    v_smfmac_f32_16x16x64_bf16 v[224:227], v[200:203], v[140:147], v7
    s_waitcnt lgkmcnt(1)
    v_smfmac_f32_16x16x64_bf16 v[224:227], v[204:207], v[148:155], v7
    s_waitcnt lgkmcnt(0)
    v_smfmac_f32_16x16x64_bf16 v[224:227], v[208:211], v[156:163], v7
    s_waitcnt vmcnt(0)
L_rs_23:
    v_cmp_neq_f32 vcc, 0x41000000, v29
    s_and_b32 s66, vcc_lo, s8
    s_cbranch_scc1 L_rt_24
    v_cvt_pk_bf16_f32 v29, 0, v29
    v_add_f32 v29, v29, v27
    s_nop 1
    v_add_f32 v224, v224, v29
    v_add_f32 v224, v224, v225
    v_cndmask_b32 v224, v28, v224, s[82:83]
    buffer_atomic_add_f32 v224, v23, s[52:55], s75 offen
L_f2s_22:
    s_add_u32 s63, s63, 360448
    s_add_u32 s70, s70, 360448
    s_add_u32 s84, s84, 360448
    s_mov_b32 s91, s19
    s_add_u32 s90, s19, s74
    s_add_u32 s75, s75, 360448
    s_add_u32 s13, s13, 4194304
    s_add_u32 s17, s63, s16
    s_add_u32 s18, s13, s16
    s_add_u32 s19, s75, s16
    s_xor_b32 s12, s17, 8192
    s_xor_b32 s14, s18, 8192
    s_xor_b32 s15, s19, 8192
    v_mov_b32 v232, -1
    v_mov_b32 v233, -1
    v_mov_b32 v234, -1
    v_mov_b32 v235, -1
    buffer_store_dwordx4 v[232:235], v17, s[52:55], s18 offen sc1
    s_waitcnt vmcnt(0)
    s_barrier
L_p_25:
    buffer_load_dwordx4 v[184:187], v168, s[52:55], s91 offen sc1
    buffer_load_dwordx4 v[188:191], v168, s[52:55], s91 offen offset:64 sc1
    s_sub_u32 s69, s69, 1
    s_cbranch_scc1 L_sl_26
L_sb_27:
    s_waitcnt vmcnt(0)
    v_min_f32 v196, v187, v191
    v_cvt_pk_bf16_f32 v180, v184, v185
    v_cmp_neq_f32 vcc, 0x41000000, v196
    v_cvt_pk_bf16_f32 v181, v186, v187
    v_cvt_pk_bf16_f32 v182, v188, v189
    v_cvt_pk_bf16_f32 v183, v190, v191
    s_and_b64 vcc, vcc, s[78:79]
    s_cbranch_scc1 L_p_25
    v_mfma_f32_16x16x32_bf16 v[196:199], v[180:183], v[32:35], 0
    v_or_b32 v220, v180, v8
    v_or_b32 v221, v181, v8
    v_mfma_f32_16x16x32_bf16 v[200:203], v[180:183], v[36:39], 0
    v_or_b32 v222, v182, v8
    v_or_b32 v223, v183, v8
    v_mfma_f32_16x16x32_bf16 v[204:207], v[180:183], v[40:43], 0
    s_nop 0
    v_mfma_f32_16x16x32_bf16 v[224:227], v[180:183], v[220:223], 0
    v_mfma_f32_16x16x32_bf16 v[208:211], v[180:183], v[44:47], 0
    v_mfma_f32_16x16x32_bf16 v[212:215], v[180:183], v[48:51], 0
    v_mfma_f32_16x16x32_bf16 v[216:219], v[180:183], v[52:55], 0
    s_nop 2
    v_add_f32 v196, v196, v205
    s_nop 1
    v_add_f32 v200, v200, v209
    v_add_f32 v229, v224, v225
    v_add_f32_dpp v228, v225, v224 quad_perm:[1,1,1,1] row_mask:0xf bank_mask:0xf
    v_add_f32 v229, v229, v226
    v_add_f32 v196, v196, v214
    v_add_f32_dpp v228, v226, v228 quad_perm:[2,2,2,2] row_mask:0xf bank_mask:0xf
    v_add_f32 v200, v200, v218
    v_cndmask_b32 v228, v228, v229, s[96:97]
    s_nop 0
    v_permlane16_swap_b32 v196, v200
    v_permlane32_swap_b32 v229, v228
    s_nop 0
    v_mov_b32_dpp v197, v196 quad_perm:[1,0,3,2] row_mask:0xf bank_mask:0xf
    v_cvt_pk_bf16_f32 v196, v196, v197
    v_cndmask_b32 v196, v229, v196, s[80:81]
    v_min_u32 v196, -2, v196
    buffer_store_dword v196, v170, s[52:55], s70 offen
    buffer_store_dword v196, v170, s[52:55], s84 offen sc1
    v_mov_b32 v196, 0
    v_mov_b32 v197, 0
    v_mov_b32 v198, 0
    v_mov_b32 v199, 0
    v_mov_b32 v212, 0
    v_mov_b32 v213, 0
    v_mov_b32 v216, 0
    v_mov_b32 v217, 0
    v_mov_b32 v220, 0
    v_mov_b32 v221, 0
    v_mov_b32 v224, 0
    v_mov_b32 v225, 0
    s_waitcnt vmcnt(0)
L_p_28:
    buffer_load_dwordx4 v[184:187], v171, s[52:55], s63 offen offset:0 sc1
    buffer_load_dwordx4 v[188:191], v171, s[52:55], s63 offen offset:1024 sc1
    buffer_load_dwordx2 v[230:231], v6, s[52:55], s63 offen offset:0 sc1
    s_sub_u32 s69, s69, 1
    s_cbranch_scc1 L_sl_29
L_sb_30:
    s_waitcnt vmcnt(0)
    v_max3_u32 v192, v184, v188, v230
    v_cmp_eq_u32 vcc, -1, v192
    s_cbranch_vccnz L_p_28
    v_smfmac_f32_16x16x64_bf16 v[196:199], v[184:187], v[56:63], v7
    v_smfmac_f32_16x16x64_bf16 v[196:199], v[188:191], v[64:71], v7
    v_add_f32_dpp v229, v231, v231 quad_perm:[1,0,3,2] row_mask:0xf bank_mask:0xf
    v_add_f32_dpp v228, v230, v230 quad_perm:[1,0,3,2] row_mask:0xf bank_mask:0xf
    s_nop 0
    v_add_f32_dpp v229, v229, v229 quad_perm:[2,3,0,1] row_mask:0xf bank_mask:0xf
    v_add_f32_dpp v228, v228, v228 quad_perm:[2,3,0,1] row_mask:0xf bank_mask:0xf
    s_nop 0
    v_add_f32_dpp v229, v229, v229 row_half_mirror row_mask:0xf bank_mask:0xf
    v_add_f32_dpp v228, v228, v228 row_half_mirror row_mask:0xf bank_mask:0xf
    v_mul_f32 v229, 0x3acccccd, v229
    v_mul_f32 v228, 0x3acccccd, v228
    v_fma_f32 v228, -v229, v229, v228
    v_max_f32 v228, 0, v228
    v_add_f32 v228, 0x3727c5ac, v228
    v_rsq_f32 v228, v228
    s_nop 0
    v_mul_f32 v228, 0x3e0293ee, v228
    v_add_f32 v196, v196, v197
    v_add_f32 v198, v198, v199
    v_add_f32 v200, v196, v198
    v_add_f32 v201, v196, v198
    s_nop 1
    v_permlane16_swap_b32 v200, v201
    v_add_f32 v202, v200, v201
    v_add_f32 v203, v200, v201
    s_nop 1
    v_permlane32_swap_b32 v202, v203
    v_add_f32 v198, v202, v203
    v_fma_f32 v198, -v229, v172, v198
    v_mul_f32 v198, v198, v228
    s_nop 1
    v_mov_b32_dpp v199, v198 quad_perm:[1,0,3,2] row_mask:0xf bank_mask:0xf
    v_cvt_pk_bf16_f32 v198, v198, v199
    v_min_u32 v198, -2, v198
    buffer_store_dword v198, v13, s[52:55], s63 offen sc1
    v_mov_b32 v228, 0
    v_mov_b32 v229, 0
    v_mov_b32 v232, 0
    v_mov_b32 v233, 0
    v_mov_b32 v236, 0
    v_mov_b32 v237, 0
    v_mov_b32 v240, 0
    v_mov_b32 v241, 0
    s_waitcnt vmcnt(0)
    buffer_load_dwordx4 v[244:247], v14, s[52:55], s17 offen offset:0 sc1
    buffer_load_dwordx4 v[248:251], v14, s[52:55], s17 offen offset:128 sc1
    buffer_load_dword v29, v179, s[52:55], s90 offen sc1
    s_waitcnt vmcnt(1)
L_top_31:
    v_max_u32 v196, v244, v248
    v_cmp_eq_u32 vcc, -1, v196
    s_cbranch_vccnz L_rt_32
    v_smfmac_f32_16x16x64_bf16 v[212:215], v[244:247], a[0:7], v7
    v_smfmac_f32_16x16x64_bf16 v[212:215], v[248:251], a[8:15], v7
    v_xor_b32 v197, 16, v10
    v_smfmac_f32_16x16x64_bf16 v[216:219], v[244:247], a[16:23], v7
    v_smfmac_f32_16x16x64_bf16 v[216:219], v[248:251], a[24:31], v7
    v_xor_b32 v252, 16, v11
    v_smfmac_f32_16x16x64_bf16 v[220:223], v[244:247], a[64:71], v7
    v_smfmac_f32_16x16x64_bf16 v[220:223], v[248:251], a[72:79], v7
    v_smfmac_f32_16x16x64_bf16 v[224:227], v[244:247], a[80:87], v7
    v_smfmac_f32_16x16x64_bf16 v[224:227], v[248:251], a[88:95], v7
    v_smfmac_f32_16x16x64_bf16 v[228:231], v[244:247], a[32:39], v7
    v_smfmac_f32_16x16x64_bf16 v[228:231], v[248:251], a[40:47], v7
    v_add_f32 v180, v212, v213
    v_smfmac_f32_16x16x64_bf16 v[232:235], v[244:247], a[48:55], v7
    v_smfmac_f32_16x16x64_bf16 v[232:235], v[248:251], a[56:63], v7
    v_add_f32 v181, v216, v217
    v_smfmac_f32_16x16x64_bf16 v[236:239], v[244:247], a[96:103], v7
    v_smfmac_f32_16x16x64_bf16 v[236:239], v[248:251], a[104:111], v7
    v_add_f32 v182, v220, v221
    v_smfmac_f32_16x16x64_bf16 v[240:243], v[244:247], a[112:119], v7
    v_smfmac_f32_16x16x64_bf16 v[240:243], v[248:251], a[120:127], v7
    v_add_f32 v183, v224, v225
    ds_write_b128 v10, v[180:183]
    v_add_f32 v184, v228, v229
    v_add_f32 v185, v232, v233
    s_nop 0
    v_add_f32 v186, v236, v237
    s_nop 1
    v_add_f32 v187, v240, v241
    ds_write_b128 v197, v[184:187] offset:1024
    s_waitcnt lgkmcnt(0)
    s_barrier
    ds_read_b128 v[180:183], v11 offset:0
    ds_read_b128 v[188:191], v11 offset:2048
    ds_read_b128 v[196:199], v11 offset:4096
    ds_read_b128 v[204:207], v11 offset:6144
    ds_read_b128 v[184:187], v252 offset:0
    ds_read_b128 v[192:195], v252 offset:2048
    ds_read_b128 v[200:203], v252 offset:4096
    ds_read_b128 v[208:211], v252 offset:6144
    v_mov_b32 v212, 0
    v_mov_b32 v213, 0
    v_mov_b32 v216, 0
    v_mov_b32 v217, 0
    v_mov_b32 v220, 0
    v_mov_b32 v221, 0
    v_mov_b32 v224, 0
    v_mov_b32 v225, 0
    v_mov_b32 v228, 0
    v_mov_b32 v229, 0
    v_mov_b32 v232, 0
    v_mov_b32 v233, 0
    v_mov_b32 v236, 0
    v_mov_b32 v237, 0
    v_mov_b32 v240, 0
    v_mov_b32 v241, 0
    s_waitcnt lgkmcnt(6)
    v_pk_add_f32 v[180:181], v[180:181], v[188:189]
    v_pk_add_f32 v[182:183], v[182:183], v[190:191]
    s_waitcnt lgkmcnt(4)
    v_pk_add_f32 v[196:197], v[196:197], v[204:205]
    v_pk_add_f32 v[198:199], v[198:199], v[206:207]
    v_pk_add_f32 v[180:181], v[180:181], v[196:197]
    v_pk_add_f32 v[182:183], v[182:183], v[198:199]
    v_max3_f32 v252, v180, v181, v182
    s_waitcnt lgkmcnt(2)
    v_pk_add_f32 v[184:185], v[184:185], v[192:193]
    v_pk_add_f32 v[186:187], v[186:187], v[194:195]
    s_waitcnt lgkmcnt(0)
    v_pk_add_f32 v[200:201], v[200:201], v[208:209]
    v_pk_add_f32 v[202:203], v[202:203], v[210:211]
    v_pk_add_f32 v[184:185], v[184:185], v[200:201]
    v_pk_add_f32 v[186:187], v[186:187], v[202:203]
    v_max3_f32 v253, v183, v184, v185
    v_max3_f32 v252, v252, v186, v187
    v_max_f32 v252, v252, v253
    v_mov_b32 v200, 0x3f803f80
    v_mov_b32 v201, 0x3f803f80
    v_max_f32_dpp v252, v252, v252 quad_perm:[1,0,3,2] row_mask:0xf bank_mask:0xf
    v_mov_b32 v202, 0x3f803f80
    v_mov_b32 v203, 0x3f803f80
    v_max_f32_dpp v253, v252, v252 quad_perm:[2,3,0,1] row_mask:0xf bank_mask:0xf
    v_max_f32_dpp v252, v252, v252 quad_perm:[2,3,0,1] row_mask:0xf bank_mask:0xf
    v_mov_b32 v204, 0x3f803f80
    v_mov_b32 v205, 0x3f803f80
    v_permlane16_swap_b32 v252, v253
    v_max_f32 v196, v252, v253
    v_max_f32 v197, v252, v253
    v_mov_b32 v206, 0x3f803f80
    v_mov_b32 v207, 0x3f803f80
    v_permlane32_swap_b32 v196, v197
    v_max_f32 v198, v196, v197
    v_pk_add_f32 v[180:181], v[180:181], v[198:199] op_sel_hi:[1,0] neg_lo:[0,1] neg_hi:[0,1]
    v_pk_add_f32 v[182:183], v[182:183], v[198:199] op_sel_hi:[1,0] neg_lo:[0,1] neg_hi:[0,1]
    v_pk_add_f32 v[184:185], v[184:185], v[198:199] op_sel_hi:[1,0] neg_lo:[0,1] neg_hi:[0,1]
    v_pk_add_f32 v[186:187], v[186:187], v[198:199] op_sel_hi:[1,0] neg_lo:[0,1] neg_hi:[0,1]
    v_exp_f32 v180, v180
    v_exp_f32 v181, v181
    v_exp_f32 v182, v182
    v_exp_f32 v183, v183
    v_exp_f32 v184, v184
    v_exp_f32 v185, v185
    v_exp_f32 v186, v186
    v_exp_f32 v187, v187
    v_cvt_pk_bf16_f32 v244, v180, v181
    v_cvt_pk_bf16_f32 v245, v182, v183
    v_cvt_pk_bf16_f32 v246, v184, v185
    v_cvt_pk_bf16_f32 v247, v186, v187
    s_nop 1
    v_smfmac_f32_16x16x64_bf16 v[212:215], v[244:247], a[128:135], v7
    v_mov_b32_dpp v248, v244 quad_perm:[2,3,2,3] row_mask:0xf bank_mask:0xf
    v_mov_b32_dpp v249, v245 quad_perm:[2,3,2,3] row_mask:0xf bank_mask:0xf
    v_smfmac_f32_16x16x64_bf16 v[216:219], v[244:247], a[144:151], v7
    v_mov_b32_dpp v250, v246 quad_perm:[2,3,2,3] row_mask:0xf bank_mask:0xf
    v_mov_b32_dpp v251, v247 quad_perm:[2,3,2,3] row_mask:0xf bank_mask:0xf
    v_smfmac_f32_16x16x64_bf16 v[220:223], v[244:247], a[160:167], v7
    v_mov_b32 v192, 0
    v_mov_b32 v193, 0
    v_smfmac_f32_16x16x64_bf16 v[224:227], v[244:247], a[176:183], v7
    v_min_u32 v198, -2, v198
    v_smfmac_f32_16x16x64_bf16 v[192:195], v[244:247], v[200:207], v7
    v_smfmac_f32_16x16x64_bf16 v[192:195], v[248:251], v[200:207], v7
    v_smfmac_f32_16x16x64_bf16 v[228:231], v[244:247], a[192:199], v7
    v_smfmac_f32_16x16x64_bf16 v[232:235], v[244:247], a[208:215], v7
    v_smfmac_f32_16x16x64_bf16 v[236:239], v[244:247], a[224:231], v7
    v_smfmac_f32_16x16x64_bf16 v[240:243], v[244:247], a[240:247], v7
    v_smfmac_f32_16x16x64_bf16 v[212:215], v[248:251], a[136:143], v7
    v_smfmac_f32_16x16x64_bf16 v[216:219], v[248:251], a[152:159], v7
    v_smfmac_f32_16x16x64_bf16 v[220:223], v[248:251], a[168:175], v7
    v_smfmac_f32_16x16x64_bf16 v[224:227], v[248:251], a[184:191], v7
    v_add_f32 v199, v192, v193
    buffer_store_dwordx2 v[198:199], v16, s[52:55], s63 offen sc1
    v_smfmac_f32_16x16x64_bf16 v[228:231], v[248:251], a[200:207], v7
    v_smfmac_f32_16x16x64_bf16 v[232:235], v[248:251], a[216:223], v7
    s_nop 0
    v_add_f32 v212, v212, v213
    v_smfmac_f32_16x16x64_bf16 v[236:239], v[248:251], a[232:239], v7
    v_add_f32 v216, v216, v217
    v_cvt_pk_bf16_f32 v208, v212, v216
    v_smfmac_f32_16x16x64_bf16 v[240:243], v[248:251], a[248:255], v7
    v_add_f32 v220, v220, v221
    v_add_f32 v224, v224, v225
    v_cvt_pk_bf16_f32 v209, v220, v224
    v_add_f32 v228, v228, v229
    v_add_f32 v232, v232, v233
    v_cvt_pk_bf16_f32 v210, v228, v232
    v_add_f32 v236, v236, v237
    s_nop 0
    v_add_f32 v240, v240, v241
    v_cvt_pk_bf16_f32 v211, v236, v240
    v_min_u32 v208, -2, v208
    buffer_store_dwordx4 v[208:211], v15, s[52:55], s18 offen sc1
    buffer_store_dwordx4 v[208:211], v15, s[52:55], s14 offen sc1
    s_waitcnt vmcnt(3)
L_rs_33:
    v_cmp_neq_f32 vcc, 0x41000000, v29
    s_and_b32 s66, vcc_lo, s9
    s_cbranch_scc1 L_rt_34
    v_cvt_pk_bf16_f32 v29, 0, v29
    s_waitcnt vmcnt(0)
L_p_35:
    buffer_load_dwordx2 v[228:229], v18, s[52:55], s17 offen sc1
    buffer_load_dwordx4 v[188:191], v17, s[52:55], s18 offen sc1
    s_sub_u32 s69, s69, 1
    s_cbranch_scc1 L_sl_36
L_sb_37:
    v_xor_b32 v223, 64, v174
    s_waitcnt vmcnt(0)
    v_max_u32 v221, v188, v228
    v_cmp_eq_u32 vcc, -1, v221
    s_cbranch_vccnz L_p_35
    ds_write_b64 v12, v[228:229]
    ds_write_b128 v173, v[188:191]
    s_waitcnt lgkmcnt(0)
    s_barrier
    ds_read_b64 v[228:229], v255
    ds_read_b128 v[188:191], v174 offset:0
    ds_read_b128 v[192:195], v223 offset:0
    ds_read_b128 v[196:199], v174 offset:2048
    ds_read_b128 v[200:203], v223 offset:2048
    s_waitcnt lgkmcnt(4)
    v_max_f32_dpp v221, v228, v228 quad_perm:[1,0,3,2] row_mask:0xf bank_mask:0xf
    s_waitcnt lgkmcnt(3)
    v_mfma_f32_16x16x32_bf16 v[204:207], v[188:191], v[72:75], 0
    v_max_f32_dpp v221, v221, v221 quad_perm:[2,3,0,1] row_mask:0xf bank_mask:0xf
    v_mfma_f32_16x16x32_bf16 v[208:211], v[188:191], v[76:79], 0
    s_waitcnt lgkmcnt(2)
    v_max_f32_dpp v222, v221, v221 row_half_mirror row_mask:0xf bank_mask:0xf
    v_max_f32_dpp v221, v221, v221 row_half_mirror row_mask:0xf bank_mask:0xf
    v_mfma_f32_16x16x32_bf16 v[204:207], v[192:195], v[80:83], v[204:207]
    v_mfma_f32_16x16x32_bf16 v[208:211], v[192:195], v[84:87], v[208:211]
    v_permlane16_swap_b32 v221, v222
    v_max_f32 v230, v221, v222
    v_max_f32 v231, v221, v222
    s_waitcnt lgkmcnt(1)
    v_mfma_f32_16x16x32_bf16 v[212:215], v[196:199], v[72:75], 0
    v_permlane32_swap_b32 v230, v231
    v_max_f32 v221, v230, v231
    v_mfma_f32_16x16x32_bf16 v[216:219], v[196:199], v[76:79], 0
    v_sub_f32 v220, v228, v221
    s_waitcnt lgkmcnt(0)
    v_mfma_f32_16x16x32_bf16 v[212:215], v[200:203], v[80:83], v[212:215]
    v_exp_f32 v220, v220
    v_mfma_f32_16x16x32_bf16 v[216:219], v[200:203], v[84:87], v[216:219]
    v_mul_f32 v229, v220, v229
    v_mul_f32_dpp v224, v220, v204 row_newbcast:0 row_mask:0xf bank_mask:0xf
    v_mul_f32_dpp v225, v220, v208 row_newbcast:0 row_mask:0xf bank_mask:0xf
    v_add_f32_dpp v221, v229, v229 quad_perm:[1,0,3,2] row_mask:0xf bank_mask:0xf
    v_mul_f32_dpp v226, v220, v205 row_newbcast:1 row_mask:0xf bank_mask:0xf
    v_mul_f32_dpp v227, v220, v209 row_newbcast:1 row_mask:0xf bank_mask:0xf
    v_add_f32_dpp v221, v221, v221 quad_perm:[2,3,0,1] row_mask:0xf bank_mask:0xf
    v_fmac_f32_dpp v224, v220, v206 row_newbcast:2 row_mask:0xf bank_mask:0xf
    v_fmac_f32_dpp v225, v220, v210 row_newbcast:2 row_mask:0xf bank_mask:0xf
    v_add_f32_dpp v222, v221, v221 row_half_mirror row_mask:0xf bank_mask:0xf
    v_add_f32_dpp v221, v221, v221 row_half_mirror row_mask:0xf bank_mask:0xf
    v_fmac_f32_dpp v226, v220, v207 row_newbcast:3 row_mask:0xf bank_mask:0xf
    v_fmac_f32_dpp v227, v220, v211 row_newbcast:3 row_mask:0xf bank_mask:0xf
    v_permlane16_swap_b32 v221, v222
    v_add_f32 v230, v221, v222
    v_add_f32 v231, v221, v222
    v_fmac_f32_dpp v224, v220, v212 row_newbcast:4 row_mask:0xf bank_mask:0xf
    v_fmac_f32_dpp v225, v220, v216 row_newbcast:4 row_mask:0xf bank_mask:0xf
    v_fmac_f32_dpp v226, v220, v213 row_newbcast:5 row_mask:0xf bank_mask:0xf
    v_fmac_f32_dpp v227, v220, v217 row_newbcast:5 row_mask:0xf bank_mask:0xf
    v_permlane32_swap_b32 v230, v231
    v_add_f32 v221, v230, v231
    v_fmac_f32_dpp v224, v220, v214 row_newbcast:6 row_mask:0xf bank_mask:0xf
    v_fmac_f32_dpp v225, v220, v218 row_newbcast:6 row_mask:0xf bank_mask:0xf
    v_rcp_f32 v221, v221
    v_fmac_f32_dpp v226, v220, v215 row_newbcast:7 row_mask:0xf bank_mask:0xf
    v_fmac_f32_dpp v227, v220, v219 row_newbcast:7 row_mask:0xf bank_mask:0xf
    v_add_f32 v224, v224, v226
    v_add_f32 v225, v225, v227
    s_nop 1
    v_permlane32_swap_b32 v224, v225
    v_add_f32 v226, v224, v225
    v_add_f32 v227, v224, v225
    s_nop 1
    v_permlane16_swap_b32 v226, v227
    v_add_f32 v224, v226, v227
    v_mul_f32 v224, v224, v221
    s_nop 1
    v_mov_b32_dpp v225, v224 quad_perm:[1,0,3,2] row_mask:0xf bank_mask:0xf
    v_cvt_pk_bf16_f32 v224, v224, v225
    v_min_u32 v224, -2, v224
    buffer_store_dword v224, v19, s[52:55], s70 offen
    buffer_store_dword v224, v19, s[52:55], s84 offen sc1
    v_mov_b32 v200, 0
    v_mov_b32 v201, 0
    v_mov_b32 v202, 0
    v_mov_b32 v203, 0
    v_mov_b32 v204, 0
    v_mov_b32 v205, 0
    v_mov_b32 v206, 0
    v_mov_b32 v207, 0
    s_waitcnt vmcnt(0)
L_p_38:
    buffer_load_dwordx4 v[188:191], v20, s[52:55], s63 offen offset:0 sc1
    buffer_load_dwordx4 v[192:195], v20, s[52:55], s63 offen offset:1024 sc1
    s_sub_u32 s69, s69, 1
    s_cbranch_scc1 L_sl_39
L_sb_40:
    s_waitcnt vmcnt(0)
    v_max_u32 v196, v188, v192
    v_cmp_eq_u32 vcc, -1, v196
    s_cbranch_vccnz L_p_38
    v_smfmac_f32_16x16x64_bf16 v[200:203], v[188:191], v[88:95], v7
    v_smfmac_f32_16x16x64_bf16 v[200:203], v[192:195], v[96:103], v7
    v_smfmac_f32_16x16x64_bf16 v[204:207], v[188:191], v[104:111], v7
    v_smfmac_f32_16x16x64_bf16 v[204:207], v[192:195], v[112:119], v7
    s_nop 5
    v_pk_add_f32 v[200:201], v[200:201], v[202:203]
    s_nop 0
    v_pk_add_f32 v[204:205], v[204:205], v[206:207]
    v_add_f32 v216, v200, v201
    v_add_f32 v217, v204, v205
    s_nop 1
    v_permlane32_swap_b32 v216, v217
    v_add_f32 v216, v216, v217
    ds_write_b32 v30, v216
    s_waitcnt lgkmcnt(0)
    s_barrier
    ds_read_b128 v[200:203], v31
    ds_read_b128 v[204:207], v31 offset:16
    s_waitcnt lgkmcnt(1)
    v_pk_add_f32 v[200:201], v[200:201], v[202:203]
    v_add_f32 v200, v200, v29
    s_waitcnt lgkmcnt(0)
    v_pk_add_f32 v[204:205], v[204:205], v[206:207]
    v_pk_add_f32 v[200:201], v[200:201], v[204:205]
    v_add_f32 v200, v200, v201
    v_cndmask_b32 v200, v28, v200, s[82:83]
    buffer_atomic_add_f32 v200, v22, s[52:55], s63 offen
    s_add_u32 s90, s17, s74
    s_waitcnt vmcnt(0) lgkmcnt(0)
    s_barrier
L_p_41:
    buffer_load_dwordx4 v[184:187], v168, s[52:55], s17 offen sc1
    buffer_load_dwordx4 v[188:191], v168, s[52:55], s17 offen offset:64 sc1
    s_sub_u32 s69, s69, 1
    s_cbranch_scc1 L_sl_42
L_sb_43:
    s_waitcnt vmcnt(0)
    v_min_f32 v196, v187, v191
    v_cvt_pk_bf16_f32 v180, v184, v185
    v_cmp_neq_f32 vcc, 0x41000000, v196
    v_cvt_pk_bf16_f32 v181, v186, v187
    v_cvt_pk_bf16_f32 v182, v188, v189
    v_cvt_pk_bf16_f32 v183, v190, v191
    s_and_b64 vcc, vcc, s[78:79]
    s_cbranch_scc1 L_p_41
    v_mfma_f32_16x16x32_bf16 v[196:199], v[180:183], v[120:123], 0
    v_or_b32 v220, v180, v8
    v_or_b32 v221, v181, v8
    v_or_b32 v222, v182, v8
    v_or_b32 v223, v183, v8
    v_mfma_f32_16x16x32_bf16 v[200:203], v[180:183], v[124:127], 0
    v_mfma_f32_16x16x32_bf16 v[204:207], v[180:183], v[128:131], 0
    v_mfma_f32_16x16x32_bf16 v[224:227], v[180:183], v[220:223], 0
    s_nop 5
    v_add_f32 v196, v196, v201
    v_add_f32 v196, v196, v206
    v_add_f32 v229, v224, v225
    v_add_f32_dpp v228, v225, v224 quad_perm:[1,1,1,1] row_mask:0xf bank_mask:0xf
    v_add_f32 v229, v229, v226
    s_nop 0
    v_add_f32_dpp v228, v226, v228 quad_perm:[2,2,2,2] row_mask:0xf bank_mask:0xf
    v_cndmask_b32 v228, v228, v229, s[96:97]
    s_nop 1
    v_permlane32_swap_b32 v229, v228
    v_cndmask_b32 v196, v229, v196, s[80:81]
    v_min_u32 v196, -2, v196
    buffer_store_dword v196, v24, s[52:55], s70 offen
    buffer_store_dword v196, v24, s[52:55], s84 offen sc1
    v_mov_b32 v194, 0xc0135761
    v_mov_b32 v224, 0
    v_mov_b32 v225, 0
    s_waitcnt vmcnt(0)
L_p_44:
    buffer_load_dwordx4 v[184:187], v25, s[52:55], s63 offen offset:0 sc1
    buffer_load_dwordx4 v[188:191], v25, s[52:55], s63 offen offset:1024 sc1
    buffer_load_dwordx2 v[230:231], v6, s[52:55], s63 offen offset:8 sc1
    s_sub_u32 s69, s69, 1
    s_cbranch_scc1 L_sl_45
L_sb_46:
    s_waitcnt vmcnt(0)
    v_max3_u32 v192, v184, v188, v230
    v_cmp_eq_u32 vcc, -1, v192
    s_cbranch_vccnz L_p_44
    buffer_load_dword v29, v179, s[52:55], s90 offen sc1
    v_add_f32_dpp v229, v231, v231 quad_perm:[1,0,3,2] row_mask:0xf bank_mask:0xf
    v_add_f32_dpp v228, v230, v230 quad_perm:[1,0,3,2] row_mask:0xf bank_mask:0xf
    v_pk_add_f32 v[212:213], v[184:185], v[188:189]
    v_pk_add_f32 v[214:215], v[186:187], v[190:191]
    v_add_f32_dpp v229, v229, v229 quad_perm:[2,3,0,1] row_mask:0xf bank_mask:0xf
    v_add_f32_dpp v228, v228, v228 quad_perm:[2,3,0,1] row_mask:0xf bank_mask:0xf
    v_permlane32_swap_b32 v212, v213
    v_permlane32_swap_b32 v214, v215
    v_add_f32_dpp v229, v229, v229 row_half_mirror row_mask:0xf bank_mask:0xf
    v_add_f32_dpp v228, v228, v228 row_half_mirror row_mask:0xf bank_mask:0xf
    v_add_f32 v212, v212, v213
    v_add_f32 v214, v214, v215
    v_mul_f32 v229, 0x3acccccd, v229
    v_mul_f32 v228, 0x3acccccd, v228
    v_permlane16_swap_b32 v212, v214
    v_fma_f32 v228, -v229, v229, v228
    v_add_f32 v192, v212, v214
    v_max_f32 v228, 0, v228
    v_add_f32 v228, 0x3727c5ac, v228
    v_rsq_f32 v228, v228
    v_fma_f32 v192, -v229, v166, v192
    v_fma_f32 v192, v192, v228, v26
    v_mul_f32 v193, v192, v192
    v_fmac_f32 v194, 0xbdd2d3e8, v193
    v_mul_f32 v193, v192, v194
    v_exp_f32 v193, v193
    s_nop 0
    v_add_f32 v193, 1.0, v193
    v_rcp_f32 v193, v193
    s_nop 0
    v_mul_f32 v192, v192, v193
    v_cvt_pk_bf16_f32 v192, v192, v192
    ds_write_b16 v9, v192
    s_cmp_ge_u32 s58, 2
    s_waitcnt lgkmcnt(0)
    s_barrier
    s_cbranch_scc1 L_f2s_47
    ds_read_b128 v[196:199], v254 offset:0
    ds_read_b128 v[200:203], v254 offset:128
    ds_read_b128 v[204:207], v254 offset:256
    ds_read_b128 v[208:211], v254 offset:384
    s_waitcnt lgkmcnt(3)
    v_smfmac_f32_16x16x64_bf16 v[224:227], v[196:199], v[132:139], v7
    s_waitcnt lgkmcnt(2)
    v_smfmac_f32_16x16x64_bf16 v[224:227], v[200:203], v[140:147], v7
    s_waitcnt lgkmcnt(1)
    v_smfmac_f32_16x16x64_bf16 v[224:227], v[204:207], v[148:155], v7
    s_waitcnt lgkmcnt(0)
    v_smfmac_f32_16x16x64_bf16 v[224:227], v[208:211], v[156:163], v7
    s_waitcnt vmcnt(0)
L_rs_48:
    v_cmp_neq_f32 vcc, 0x41000000, v29
    s_and_b32 s66, vcc_lo, s8
    s_cbranch_scc1 L_rt_49
    v_cvt_pk_bf16_f32 v29, 0, v29
    v_add_f32 v29, v29, v27
    s_nop 1
    v_add_f32 v224, v224, v29
    v_add_f32 v224, v224, v225
    v_cndmask_b32 v224, v28, v224, s[82:83]
    v_mov_b32 v225, v224
    buffer_atomic_add_f32 v224, v4, s[52:55], s75 offen sc0
    s_waitcnt vmcnt(0)
    v_readlane_b32 s66, v224, 15
    v_add_f32 v224, v224, v225
    v_cvt_pk_bf16_f32 v224, v224, v224
    s_cmp_eq_u32 s66, 0x40e00000
    s_cselect_b32 s66, s86, 536870912
    buffer_store_short v224, v167, s[44:47], s66 offen
L_f2s_47:
L_fin:
L_end:
    s_endpgm
L_rt_2:
    buffer_load_dwordx4 v[240:243], v116, s[52:55], 0 offen sc1
    s_sub_u32 s69, s69, 1
    s_cbranch_scc1 L_sl_50
L_sb_51:
    s_waitcnt vmcnt(0)
    s_branch L_fl_1
L_rt_4:
    buffer_load_dwordx4 v[232:235], v171, s[52:55], s98 offen offset:0 sc1
    buffer_load_dwordx4 v[236:239], v171, s[52:55], s98 offen offset:1024 sc1
    buffer_load_dwordx4 v[184:187], v171, s[52:55], s63 offen offset:0 sc1
    buffer_load_dwordx4 v[188:191], v171, s[52:55], s63 offen offset:1024 sc1
    buffer_load_dwordx2 v[230:231], v6, s[52:55], s63 offen offset:0 sc1
    s_sub_u32 s69, s69, 1
    s_cbranch_scc1 L_sl_52
L_sb_53:
    s_waitcnt vmcnt(0)
    s_branch L_qc_3
L_rt_6:
    buffer_load_dwordx4 v[240:243], v157, s[52:55], 0 offen sc1
    s_sub_u32 s69, s69, 1
    s_cbranch_scc1 L_sl_54
L_sb_55:
    s_waitcnt vmcnt(0)
    s_branch L_fl_5
L_rt_8:
    buffer_load_dwordx4 v[244:247], v14, s[52:55], s17 offen offset:0 sc1
    buffer_load_dwordx4 v[248:251], v14, s[52:55], s17 offen offset:128 sc1
    s_sub_u32 s69, s69, 1
    s_cbranch_scc1 L_sl_56
L_sb_57:
    s_waitcnt vmcnt(0)
    s_branch L_top_7
L_rt_10:
    buffer_load_dwordx4 v[112:115], v158, s[52:55], 0 offen sc1
    s_sub_u32 s69, s69, 1
    s_cbranch_scc1 L_sl_58
L_sb_59:
    s_waitcnt vmcnt(0)
    s_branch L_fl_9
L_rt_12:
    buffer_load_dwordx2 v[228:229], v18, s[52:55], s17 offen sc1
    buffer_load_dwordx4 v[188:191], v17, s[52:55], s18 offen sc1
    s_sub_u32 s69, s69, 1
    s_cbranch_scc1 L_sl_60
L_sb_61:
    s_waitcnt vmcnt(0)
    s_branch L_h2_11
L_rt_24:
    buffer_load_dword v29, v179, s[52:55], s90 offen sc1
    s_sub_u32 s69, s69, 1
    s_cbranch_scc1 L_sl_62
L_sb_63:
    s_waitcnt vmcnt(0)
    s_branch L_rs_23
L_rt_32:
    buffer_load_dwordx4 v[244:247], v14, s[52:55], s17 offen offset:0 sc1
    buffer_load_dwordx4 v[248:251], v14, s[52:55], s17 offen offset:128 sc1
    s_sub_u32 s69, s69, 1
    s_cbranch_scc1 L_sl_64
L_sb_65:
    s_waitcnt vmcnt(0)
    s_branch L_top_31
L_rt_34:
    buffer_load_dword v29, v179, s[52:55], s90 offen sc1
    s_sub_u32 s69, s69, 1
    s_cbranch_scc1 L_sl_66
L_sb_67:
    s_waitcnt vmcnt(0)
    s_branch L_rs_33
L_rt_49:
    buffer_load_dword v29, v179, s[52:55], s90 offen sc1
    s_sub_u32 s69, s69, 1
    s_cbranch_scc1 L_sl_68
L_sb_69:
    s_waitcnt vmcnt(0)
    s_branch L_rs_48
L_sl_14:
    s_call_b64 s[50:51], L_refresh
    s_branch L_sb_15
L_sl_17:
    s_call_b64 s[50:51], L_refresh
    s_branch L_sb_18
L_sl_20:
    s_call_b64 s[50:51], L_refresh
    s_branch L_sb_21
L_sl_26:
    s_call_b64 s[50:51], L_refresh
    s_branch L_sb_27
L_sl_29:
    s_call_b64 s[50:51], L_refresh
    s_branch L_sb_30
L_sl_36:
    s_call_b64 s[50:51], L_refresh
    s_branch L_sb_37
L_sl_39:
    s_call_b64 s[50:51], L_refresh
    s_branch L_sb_40
L_sl_42:
    s_call_b64 s[50:51], L_refresh
    s_branch L_sb_43
L_sl_45:
    s_call_b64 s[50:51], L_refresh
    s_branch L_sb_46
L_sl_50:
    s_call_b64 s[50:51], L_refresh
    s_branch L_sb_51
L_sl_52:
    s_call_b64 s[50:51], L_refresh
    s_branch L_sb_53
L_sl_54:
    s_call_b64 s[50:51], L_refresh
    s_branch L_sb_55
L_sl_56:
    s_call_b64 s[50:51], L_refresh
    s_branch L_sb_57
L_sl_58:
    s_call_b64 s[50:51], L_refresh
    s_branch L_sb_59
L_sl_60:
    s_call_b64 s[50:51], L_refresh
    s_branch L_sb_61
L_sl_62:
    s_call_b64 s[50:51], L_refresh
    s_branch L_sb_63
L_sl_64:
    s_call_b64 s[50:51], L_refresh
    s_branch L_sb_65
L_sl_66:
    s_call_b64 s[50:51], L_refresh
    s_branch L_sb_67
L_sl_68:
    s_call_b64 s[50:51], L_refresh
    s_branch L_sb_69
L_refresh:
    s_sub_u32 s3, s3, 1
    s_cbranch_scc1 L_end
    s_memrealtime s[88:89]
    s_mov_b32 s69, 40
    s_waitcnt lgkmcnt(0)
    v_mov_b32 v0, s88
    v_mov_b32 v1, s89
    buffer_store_dwordx2 v[0:1], v169, s[52:55], 0 offen sc1
    buffer_store_dwordx2 v[0:1], v169, s[52:55], s48 offen sc1
    s_waitcnt vmcnt(0)
    v_mbcnt_lo_u32_b32 v1, -1, 0
    v_mbcnt_hi_u32_b32 v1, -1, v1
    v_lshl_add_u32 v0, s58, 6, v1
    s_setpc_b64 s[50:51]
L_codeend:
.section .rodata,"a"
.p2align 6
.amdhsa_kernel interleave_layers__compressed_kv_cla__dense_activation_gelu__decode_kernel
  .amdhsa_next_free_vgpr 512
  .amdhsa_next_free_sgpr 102
  .amdhsa_accum_offset 256
  .amdhsa_group_segment_fixed_size 0
  .amdhsa_kernarg_size 112
  .amdhsa_user_sgpr_count 2
  .amdhsa_user_sgpr_kernarg_segment_ptr 1
  .amdhsa_system_sgpr_workgroup_id_x 1
.end_amdhsa_kernel
```
